```python
import torch

def _softmax(x, axis=-1):
    return torch.softmax(x, dim=axis)
def _gelu(x):
    return torch.nn.functional.gelu(x, approximate="tanh")
def _silu(x):
    return torch.nn.functional.silu(x)
def _sigmoid(x):
    return torch.sigmoid(x)
def _layernorm(x, axis=-1, eps=1e-5):
    m = x.mean(dim=axis, keepdim=True)
    v = x.var(dim=axis, keepdim=True, unbiased=False)
    return (x - m) / torch.sqrt(v + eps)
def _scatter_add(tgt, idx, src, axis=0):
    return tgt.clone().index_add_(axis, idx, src)
def _segment_sum(src, seg, n):
    out = torch.zeros((n,) + src.shape[1:], dtype=src.dtype)
    return out.index_add_(0, seg, src)
def _pad(x, pw):
    flat = tuple(v for pair in reversed(pw) for v in pair)
    return torch.nn.functional.pad(x, flat)

kernel_name = 'interleave_layers__softmax_full_mha__glu_gated_reglu__prompt'

def setup_inputs():

    _w = (lambda a: (lambda t: t.to(torch.bfloat16) if t.is_floating_point() else t)(torch.as_tensor(a)))
    def _A_setup():
        B, S, D = 1, 2048, 640
        return {
            "x": _w((lambda *s: torch.randn(*s, dtype=torch.bfloat16) * 0.05)(B, S, D)),
            "wqkv": _w((lambda *s: torch.randn(*s, dtype=torch.bfloat16) * 0.05)(D, 3 * D)),
            "wo": _w((lambda *s: torch.randn(*s, dtype=torch.bfloat16) * 0.05)(D, D)),
        }
    _A_in = _A_setup()

    def _B_setup():
        B, S, D, F = 1, 2048, 640, 1536
        return {
            "x": _w((lambda *s: torch.randn(*s, dtype=torch.bfloat16) * 0.05)(B, S, D)),
            "W_gate": _w((lambda *s: torch.randn(*s, dtype=torch.bfloat16) * 0.8)(D, F) * (2.0 / D) ** 0.5),
            "W_up": _w((lambda *s: torch.randn(*s, dtype=torch.bfloat16) * 0.8)(D, F) * (2.0 / D) ** 0.5),
            "W_down": _w((lambda *s: torch.randn(*s, dtype=torch.bfloat16) * 0.8)(F, D) * (1.0 / F) ** 0.5),
        }
    _B_in = _B_setup()

    return {
        "A_x": _A_in["x"],
        "A_wqkv": _A_in["wqkv"],
        "A_wo": _A_in["wo"],
        "B_x": _B_in["x"],
        "B_W_gate": _B_in["W_gate"],
        "B_W_up": _B_in["W_up"],
        "B_W_down": _B_in["W_down"],
    }

def reference(A_x, A_wqkv, A_wo, B_x, B_W_gate, B_W_up, B_W_down):
    def _A_ref(x, wqkv, wo):
        B, S, D = x.shape
        H = 32; Dh = D // H
        qkv = (lambda x, *d: x.permute(*d))((x @ wqkv).reshape(B, S, 3, H, Dh), 2, 0, 3, 1, 4)
        q, k, v = qkv[0], qkv[1], qkv[2]
        scale = Dh ** -0.5
        scores = torch.einsum("bhqd,bhkd->bhqk", q, k) * scale
        p = _softmax(scores, axis=-1)
        o = torch.einsum("bhqk,bhkd->bhqd", p, v)
        return (lambda x, *d: x.permute(*d))(o, 0, 2, 1, 3).reshape(B, S, D) @ wo

    def _B_ref(x, W_gate, W_up, W_down):
        gate = torch.einsum("bsd,df->bsf", x, W_gate)
        up = torch.einsum("bsd,df->bsf", x, W_up)
        gate = gate * (lambda x, dt: x.to(dt))(gate > 0, gate.dtype)
        h = gate * up
        return torch.einsum("bsf,fd->bsd", h, W_down)

    x = A_x
    x = x + _A_ref(_layernorm(x, axis=-1), A_wqkv, A_wo)
    x = x + _B_ref(_layernorm(x, axis=-1), B_W_gate, B_W_up, B_W_down)
    x = x + _A_ref(_layernorm(x, axis=-1), A_wqkv, A_wo)
    x = x + _B_ref(_layernorm(x, axis=-1), B_W_gate, B_W_up, B_W_down)
    return x
```

```asm
; @launch kernel=interleave_layers__softmax_full_mha__glu_gated_reglu__prompt_kernel grid=(256,1,1) block=(512,1,1) lds=163840
.amdgcn_target "amdgcn-amd-amdhsa--gfx950"
.text
.globl interleave_layers__softmax_full_mha__glu_gated_reglu__prompt_kernel
.p2align 8
.type interleave_layers__softmax_full_mha__glu_gated_reglu__prompt_kernel,@function
interleave_layers__softmax_full_mha__glu_gated_reglu__prompt_kernel:
    s_cmp_ge_u32 s2, 256
    s_cbranch_scc1 L_exit
    s_load_dwordx4 s[60:63], s[0:1], 0
    s_load_dwordx2 s[64:65], s[0:1], 56
    s_load_dwordx4 s[68:71], s[0:1], 64
    s_memrealtime s[66:67]
    s_getpc_b64 s[90:91]
L_pc_ref:
    s_lshr_b32 s5, s2, 3
    s_and_b32 s44, s5, 15
    s_lshl_b32 s44, s44, 11
    v_lshl_add_u32 v2, v0, 2, s44
    v_min_u32 v2, 0x7ba0, v2
    global_load_dword v239, v2, s[90:91]
    v_and_b32 v1, 63, v0
    v_lshrrev_b32 v2, 6, v0
    s_and_b32 s4, s2, 7
    v_readfirstlane_b32 s3, v2
    s_lshr_b32 s34, s4, 1
    s_lshl_b32 s34, s34, 2
    s_and_b32 s44, s5, 3
    s_add_u32 s34, s34, s44
    s_and_b32 s35, s4, 1
    s_lshl_b32 s35, s35, 3
    s_lshr_b32 s44, s5, 2
    s_add_u32 s35, s35, s44
    s_and_b32 s6, s3, 3
    s_cmp_ge_u32 s3, 4
    s_cbranch_scc1 L_qkv_l0
    s_branch L_c0
S_qw:
    s_lshl_b32 s44, s6, 12
    s_add_u32 m0, s53, s44
    s_add_u32 s53, s53, 16384
    s_cmp_eq_u32 s53, 163840
    s_cselect_b32 s53, 81920, s53
    buffer_load_dwordx4 v8, s[12:15], s51 offen offset:0 lds
    buffer_load_dwordx4 v9, s[12:15], s51 offen offset:1024 lds
    buffer_load_dwordx4 v10, s[12:15], s51 offen offset:2048 lds
    buffer_load_dwordx4 v11, s[12:15], s51 offen offset:3072 lds
    s_add_u32 s51, s51, 245760
    s_sub_u32 s44, s51, 2457600
    s_cmp_eq_u32 s51, s56
    s_cselect_b32 s51, s44, s51
    s_setpc_b64 s[32:33]
S_qx:
    s_lshl_b32 s44, s6, 12
    s_add_u32 m0, s52, s44
    s_add_u32 s52, s52, 16384
    s_cmp_eq_u32 s52, 81920
    s_cselect_b32 s52, 0, s52
    buffer_load_dwordx4 v4, s[20:23], s50 offen offset:0 sc1 lds
    buffer_load_dwordx4 v5, s[20:23], s50 offen offset:1024 sc1 lds
    buffer_load_dwordx4 v6, s[20:23], s50 offen offset:2048 sc1 lds
    buffer_load_dwordx4 v7, s[20:23], s50 offen offset:3072 sc1 lds
    s_add_u32 s50, s50, s54
    s_sub_u32 s44, s50, 1280
    s_cmp_eq_u32 s50, s55
    s_cselect_b32 s50, s44, s50
    s_setpc_b64 s[32:33]
L_qkv_l0:
    v_bfe_u32 v8, v1, 2, 2
    v_mul_u32_u24 v8, 3840, v8
    v_lshrrev_b32 v2, 4, v1
    v_lshl_add_u32 v8, v2, 6, v8
    v_and_b32 v2, 3, v1
    v_lshl_add_u32 v8, v2, 4, v8
    v_xor_b32 v2, 32, v8
    v_add_u32 v9, 14336, v8
    v_add_u32 v10, 28672, v2
    v_add_u32 v11, 43008, v2
    s_mul_i32 s51, s6, 61440
    s_lshl_b32 s44, s35, 8
    s_add_u32 s51, s51, s44
    s_mov_b32 s53, 131072
    s_mov_b32 s56, 1
    s_mul_i32 s57, s34, 3
    s_add_u32 s57, s57, s35
    s_mul_i32 s44, s57, 26
    s_lshr_b32 s44, s44, 8
    s_mul_i32 s44, s44, 10
    s_sub_u32 s57, s57, s44
    s_add_u32 s56, s51, 2457600
    s_mul_i32 s44, s57, 245760
    s_add_u32 s51, s51, s44
    v_lshrrev_b32 v40, 3, v1
    v_and_b32 v41, 7, v1
    v_lshrrev_b32 v42, 4, v1
    v_xor_b32 v41, v41, v42
    v_mul_u32_u24 v40, 1280, v40
    v_xor_b32 v42, 0, v41
    v_lshl_add_u32 v4, v42, 4, v40
    v_xor_b32 v42, 4, v41
    v_lshl_add_u32 v5, v42, 4, v40
    v_add_u32 v5, 9216, v5
    v_xor_b32 v42, 0, v41
    v_lshl_add_u32 v6, v42, 4, v40
    v_add_u32 v6, 18432, v6
    v_xor_b32 v42, 4, v41
    v_lshl_add_u32 v7, v42, 4, v40
    v_add_u32 v7, 27648, v7
    s_lshl_b32 s50, s34, 2
    s_add_u32 s50, s50, s6
    s_mul_i32 s50, s50, 40960
    s_mov_b32 s54, 128
    s_mov_b32 s52, 49152
    s_add_u32 s55, s50, 1280
    s_lshl_b32 s44, s57, 7
    s_add_u32 s50, s50, s44
    s_waitcnt lgkmcnt(0)
    s_mov_b32 s12, s62
    s_mov_b32 s13, s63
    s_mov_b32 s14, 2457600
    s_mov_b32 s15, 0x00020000
    s_mov_b32 s8, s60
    s_mov_b32 s9, s61
    s_mov_b32 s10, 2621440
    s_mov_b32 s11, 0x00020000
    s_mov_b32 s20, s8
    s_mov_b32 s21, s9
    s_mov_b32 s22, s10
    s_mov_b32 s23, s11
    s_cmp_eq_u32 s35, 15
    s_cbranch_scc1 L_qkv_l0b
    s_call_b64 s[32:33], S_qw
    s_call_b64 s[32:33], S_qx
    s_call_b64 s[32:33], S_qw
    s_call_b64 s[32:33], S_qx
L_qkv_l0b:
    s_mov_b32 s16, s64
    s_mov_b32 s17, s65
    s_mov_b32 s18, 2621440
    s_mov_b32 s19, 0x00020000
    s_mov_b32 s24, s70
    s_mov_b32 s25, s71
    s_mov_b32 s26, 51888128
    s_mov_b32 s27, 0x00020000
    s_mov_b32 s30, s68
    s_mov_b32 s31, s69
    s_lshl_b32 s28, s66, 4
    s_or_b32 s28, s28, 8
    s_mov_b32 s29, 0
    s_mov_b32 s7, 0
    s_lshl_b32 s36, s4, 2
    s_and_b32 s44, s5, 3
    s_add_u32 s36, s36, s44
    s_lshr_b32 s37, s5, 2
    s_mov_b32 s40, s36
    s_mov_b32 s41, s37
    s_lshl_b32 s38, s4, 1
    s_and_b32 s44, s5, 1
    s_add_u32 s38, s38, s44
    s_lshr_b32 s39, s5, 1
    s_mov_b32 s42, 0x000fffff
    s_mov_b32 s43, 0x000fffff
    v_mov_b32 v240, 0
    v_mov_b32 v241, 0
    s_cmp_eq_u32 s35, 15
    s_cbranch_scc1 L_att
    s_setprio 3
    v_mov_b32 v60, 0
    v_and_b32 v13, 31, v1
    s_lshl_b32 s44, s6, 7
    v_lshl_add_u32 v13, v13, 2, s44
    v_lshlrev_b32 v14, 1, v13
    s_lshl_b32 s49, s35, 10
    s_add_u32 s49, s49, 51380224
    v_lshrrev_b32 v15, 5, v1
    v_mul_u32_u24 v15, 81920, v15
    v_add_u32 v15, v15, v14
    v_and_b32 v40, 31, v1
    v_lshrrev_b32 v41, 5, v1
    v_lshlrev_b32 v132, 4, v40
    v_mul_u32_u24 v133, 163840, v41
    v_add_u32 v133, v133, v132
    s_lshl_b32 s48, s34, 11
    s_lshl_b32 s44, s6, 9
    s_add_u32 s48, s48, s44
    s_add_u32 s48, s48, 53248
    s_waitcnt vmcnt(8)
    s_barrier
    s_call_b64 s[32:33], S_qw
    s_call_b64 s[32:33], S_qx
    s_call_b64 s[32:33], S_qw
    s_call_b64 s[32:33], S_qx
    s_waitcnt vmcnt(16)
    s_barrier
    s_call_b64 s[32:33], S_qw
    s_call_b64 s[32:33], S_qx
    s_waitcnt vmcnt(16)
    s_barrier
    s_call_b64 s[32:33], S_qw
    s_call_b64 s[32:33], S_qx
    s_waitcnt vmcnt(16)
    s_barrier
    s_call_b64 s[32:33], S_qw
    s_call_b64 s[32:33], S_qx
    s_waitcnt vmcnt(16)
    s_barrier
    s_call_b64 s[32:33], S_qw
    s_call_b64 s[32:33], S_qx
    s_waitcnt vmcnt(16)
    s_barrier
    s_call_b64 s[32:33], S_qw
    s_call_b64 s[32:33], S_qx
    s_waitcnt vmcnt(16)
    s_barrier
    s_call_b64 s[32:33], S_qw
    s_call_b64 s[32:33], S_qx
    s_waitcnt vmcnt(16)
    s_barrier
    global_load_dword v62, v60, s[30:31] sc1
    s_call_b64 s[32:33], S_gl
    s_waitcnt vmcnt(19)
    s_barrier
    s_waitcnt vmcnt(11)
    s_barrier
    s_waitcnt vmcnt(0)
    v_readfirstlane_b32 s28, v62
    s_mov_b32 s45, 0x8000
Lx_1:
    v_min3_u32 v60, v73, v75, v77
    v_max3_u32 v61, v73, v75, v77
    v_min3_u32 v60, v60, v79, v81
    v_max3_u32 v61, v61, v79, v81
    v_min3_u32 v60, v60, v85, v87
    v_max3_u32 v61, v61, v85, v87
    v_min3_u32 v60, v60, v89, v91
    v_max3_u32 v61, v61, v89, v91
    v_min3_u32 v60, v60, v93, v95
    v_max3_u32 v61, v61, v93, v95
    v_min3_u32 v60, v60, v97, v99
    v_max3_u32 v61, v61, v97, v99
    v_min3_u32 v60, v60, v101, v103
    v_max3_u32 v61, v61, v101, v103
    v_cmp_ne_u32 vcc, s28, v60
    v_cmp_ne_u32 s[60:61], s28, v61
    s_sub_u32 s45, s45, 1
    s_cmp_eq_u32 s45, 0
    s_cbranch_scc1 Lx_2
    s_or_b64 vcc, vcc, s[60:61]
    s_cbranch_scc0 Lx_2
    s_call_b64 s[32:33], S_gl
    s_waitcnt vmcnt(0)
    s_branch Lx_1
Lx_2:
    v_add_f32 v84, v84, v88
    v_add_f32 v86, v86, v90
    v_add_f32 v84, v84, v92
    v_add_f32 v86, v86, v94
    v_add_f32 v84, v84, v96
    v_add_f32 v86, v86, v98
    v_add_f32 v84, v84, v100
    v_add_f32 v86, v86, v102
    v_mov_b32 v60, v84
    v_mov_b32 v61, v86
    s_nop 1
    v_permlane32_swap_b32 v60, v84
    v_permlane32_swap_b32 v61, v86
    s_nop 0
    v_add_f32 v60, v60, v84
    v_add_f32 v61, v61, v86
    v_mul_f32 v60, 0x3acccccd, v60
    v_mul_f32 v61, 0x3acccccd, v61
    v_fma_f32 v61, -v60, v60, v61
    v_max_f32 v61, 0, v61
    v_add_f32 v61, 0x3727c5ac, v61
    v_rsq_f32 v61, v61
    s_nop 0
    ds_write2_b32 v13, v60, v61 offset1:128
    v_add_f32 v72, v72, v74
    v_add_f32 v72, v72, v76
    v_add_f32 v72, v72, v78
    v_add_f32 v72, v72, v80
    v_mov_b32 v73, v72
    s_nop 1
    v_permlane32_swap_b32 v72, v73
    s_nop 0
    v_add_f32 v72, v72, v73
    ds_write_b32 v13, v72 offset:1024
    s_waitcnt lgkmcnt(0)
    s_barrier
    s_setprio 0
    s_branch L_att
L_qkv_l1:
    s_mov_b32 s20, s24
    s_mov_b32 s21, s25
    s_mov_b32 s22, s26
    s_mov_b32 s23, s27
    v_lshlrev_b32 v4, 4, v1
    v_add_u32 v6, 18432, v4
    v_lshlrev_b32 v5, 4, v1
    v_add_u32 v7, 18432, v5
    s_lshl_b32 s50, s34, 2
    s_add_u32 s50, s50, s6
    s_mul_i32 s50, s50, 40960
    s_add_u32 s50, s50, 22380544
    s_mov_b32 s54, 2048
    s_mov_b32 s52, 49152
    s_mov_b32 s55, 1
    s_barrier
    s_cmp_eq_u32 s35, 15
    s_cbranch_scc1 L_att
    s_setprio 0
    s_call_b64 s[32:33], S_qx
    s_call_b64 s[32:33], S_qx
    s_waitcnt vmcnt(4)
    s_barrier
    s_call_b64 s[32:33], S_qx
    s_call_b64 s[32:33], S_qx
    s_waitcnt vmcnt(8)
    s_waitcnt lgkmcnt(0)
    s_barrier
    s_call_b64 s[32:33], S_qw
    s_waitcnt vmcnt(8)
    s_barrier
    s_call_b64 s[32:33], S_qx
    s_call_b64 s[32:33], S_qw
    s_waitcnt vmcnt(12)
    s_barrier
    s_call_b64 s[32:33], S_qx
    v_and_b32 v68, 31, v1
    v_lshlrev_b32 v68, 3, v68
    v_lshrrev_b32 v69, 5, v1
    v_lshl_add_u32 v69, v69, 16, v68
    s_lshl_b32 s44, s34, 10
    s_lshl_b32 s45, s6, 8
    s_add_u32 s44, s44, s45
    s_add_u32 s44, s44, s7
    s_add_u32 s44, s44, 5292032
    buffer_load_dwordx2 v[60:61], v69, s[24:27], s44 offen sc1
    s_add_u32 s44, s44, 16384
    buffer_load_dwordx2 v[62:63], v69, s[24:27], s44 offen sc1
    s_add_u32 s44, s44, 16384
    buffer_load_dwordx2 v[64:65], v69, s[24:27], s44 offen sc1
    s_add_u32 s44, s44, 16384
    buffer_load_dwordx2 v[66:67], v69, s[24:27], s44 offen sc1
    s_add_u32 s45, s45, 0
    v_add_u32 v68, s45, v68
    v_lshrrev_b32 v68, 1, v68
    s_waitcnt vmcnt(12)
    s_barrier
    s_call_b64 s[32:33], S_qx
    s_call_b64 s[32:33], S_qw
    s_waitcnt vmcnt(12)
    s_barrier
    s_call_b64 s[32:33], S_qx
    s_call_b64 s[32:33], S_qw
    s_waitcnt vmcnt(12)
    s_barrier
    s_call_b64 s[32:33], S_qx
    s_call_b64 s[32:33], S_qw
    s_waitcnt vmcnt(12)
    s_barrier
    s_call_b64 s[32:33], S_qx
    s_waitcnt vmcnt(8)
    s_barrier
    s_waitcnt vmcnt(0)
    s_barrier
    v_add_f32 v60, v60, v62
    v_add_f32 v61, v61, v63
    v_add_f32 v64, v64, v66
    v_add_f32 v65, v65, v67
    v_add_f32 v60, v60, v64
    v_add_f32 v61, v61, v65
    v_mov_b32 v62, v60
    v_mov_b32 v63, v61
    s_nop 1
    v_permlane32_swap_b32 v60, v62
    v_permlane32_swap_b32 v61, v63
    s_nop 0
    v_add_f32 v60, v60, v62
    v_add_f32 v61, v61, v63
    v_mul_f32 v60, 0x3acccccd, v60
    v_mul_f32 v61, 0x3acccccd, v61
    v_fma_f32 v61, -v60, v60, v61
    v_max_f32 v61, 0, v61
    v_add_f32 v61, 0x3727c5ac, v61
    v_rsq_f32 v61, v61
    s_nop 0
    ds_write2_b32 v68, v60, v61 offset1:128
    v_add_f32 v72, v72, v74
    v_add_f32 v72, v72, v76
    v_add_f32 v72, v72, v78
    v_add_f32 v72, v72, v80
    v_mov_b32 v73, v72
    s_nop 1
    v_permlane32_swap_b32 v72, v73
    s_nop 0
    v_add_f32 v72, v72, v73
    ds_write_b32 v13, v72 offset:1024
    s_waitcnt lgkmcnt(0)
    s_barrier
    s_setprio 0
    s_branch L_att
L_c0:
    s_waitcnt lgkmcnt(0)
    s_mov_b32 s12, s62
    s_mov_b32 s13, s63
    s_mov_b32 s14, 2457600
    s_mov_b32 s15, 0x00020000
    s_mov_b32 s8, s60
    s_mov_b32 s9, s61
    s_mov_b32 s10, 2621440
    s_mov_b32 s11, 0x00020000
    s_mov_b32 s16, s64
    s_mov_b32 s17, s65
    s_mov_b32 s18, 2621440
    s_mov_b32 s19, 0x00020000
    s_mov_b32 s24, s70
    s_mov_b32 s25, s71
    s_mov_b32 s26, 51888128
    s_mov_b32 s27, 0x00020000
    s_mov_b32 s30, s68
    s_mov_b32 s31, s69
    s_lshl_b32 s28, s66, 4
    s_or_b32 s28, s28, 8
    s_mov_b32 s29, 0
    s_mov_b32 s7, 0
    s_lshl_b32 s36, s4, 2
    s_and_b32 s44, s5, 3
    s_add_u32 s36, s36, s44
    s_lshr_b32 s37, s5, 2
    s_mov_b32 s40, s36
    s_mov_b32 s41, s37
    s_lshl_b32 s38, s4, 1
    s_and_b32 s44, s5, 1
    s_add_u32 s38, s38, s44
    s_lshr_b32 s39, s5, 1
    s_mov_b32 s42, 0x000fffff
    s_mov_b32 s43, 0x000fffff
    v_mov_b32 v240, 0
    v_mov_b32 v241, 0
    s_or_b32 s44, s2, s3
    s_cmp_lg_u32 s44, 0
    s_cbranch_scc1 L_nonce_done
    s_mov_b64 exec, 1
    v_mov_b32 v4, s28
    v_mov_b32 v6, 0
    s_nop 0
    global_store_dword v6, v4, s[30:31] sc0 sc1
    s_mov_b64 exec, -1
L_nonce_done:
    v_and_b32 v3, 15, v1
    v_lshrrev_b32 v4, 4, v1
    v_mul_u32_u24 v3, 1280, v3
    v_lshl_add_u32 v3, v4, 3, v3
    s_lshl_b32 s60, s36, 2
    s_add_u32 s60, s60, s3
    s_mul_i32 s60, s60, 20480
    s_mul_i32 s61, s37, 160
    s_add_u32 s60, s60, s61
    buffer_load_dwordx2 v[246:247], v3, s[8:11], s60 offen offset:0
    buffer_load_dwordx2 v[248:249], v3, s[8:11], s60 offen offset:32
    buffer_load_dwordx2 v[250:251], v3, s[8:11], s60 offen offset:64
    buffer_load_dwordx2 v[252:253], v3, s[8:11], s60 offen offset:96
    buffer_load_dwordx2 v[254:255], v3, s[8:11], s60 offen offset:128
    v_and_b32 v5, 15, v1
    v_lshrrev_b32 v6, 5, v1
    v_lshlrev_b32 v7, 2, v6
    v_lshl_add_u32 v241, v5, 3, v7
    v_lshlrev_b32 v6, 8, v6
    v_lshl_add_u32 v6, v5, 4, v6
    v_bfe_u32 v5, v1, 4, 1
    v_lshl_add_u32 v240, v5, 3, v6
    s_lshl_b32 s62, s36, 2
    s_add_u32 s62, s62, s3
    s_mul_i32 s84, s62, 20480
    s_mul_i32 s63, s37, 2560
    s_add_u32 s84, s84, s63
    s_lshl_b32 s62, s62, 7
    s_lshl_b32 s63, s37, 14
    s_add_u32 s85, s62, s63
    s_mul_i32 s63, s3, 5120
    v_lshl_add_u32 v242, v1, 4, s63
    s_xor_b32 s63, s3, 1
    s_mul_i32 s63, s63, 5120
    v_lshl_add_u32 v243, v1, 4, s63
L_qkv_c:
    s_and_b32 s60, s3, 1
    s_lshr_b32 s61, s3, 1
    v_and_b32 v3, 15, v1
    v_lshrrev_b32 v4, 4, v1
    s_lshl_b32 s62, s34, 1
    s_add_u32 s62, s62, s61
    s_lshl_b32 s63, s35, 7
    s_lshl_b32 s64, s60, 6
    s_add_u32 s63, s63, s64
    s_cmp_ge_u32 s35, 10
    s_cbranch_scc1 L_qkv_c_vpro
    s_cmp_lt_u32 s35, 5
    s_mov_b32 s65, 163840
    s_cselect_b32 s65, 81920, s65
    s_mov_b32 s66, 5120
    s_cselect_b32 s66, 2560, s66
    s_mov_b32 s67, 8175616
    s_cselect_b32 s67, 5554176, s67
    s_cselect_b32 s68, 0, 640
    s_cselect_b32 s69, 0x3ea52b5c, 1.0
    s_mul_i32 s66, s66, s62
    s_add_u32 s67, s67, s66
    s_add_u32 s67, s67, s7
    s_sub_u32 s68, s63, s68
    s_lshr_b32 s68, s68, 2
    v_add_u32 v2, s68, v4
    s_mov_b32 s64, 0x83120
    s_mov_b32 s66, 0x14444
    v_and_b32 v7, 9, v3
    v_lshlrev_b32 v7, 4, v7
    v_and_b32 v5, 4, v3
    v_lshl_add_u32 v7, v5, 3, v7
    v_and_b32 v5, 2, v3
    v_lshl_add_u32 v7, v5, 5, v7
    v_add_u32 v5, 0, v2
    v_mul_u32_u24 v6, 205, v5
    v_lshrrev_b32 v6, 10, v6
    v_mad_u32_u24 v144, v6, s65, v7
    v_mul_u32_u24 v6, 20, v6
    v_lshlrev_b32 v5, 2, v5
    v_sub_u32 v5, v5, v6
    v_bfe_u32 v6, s64, v5, 4
    v_bfe_u32 v5, s66, v5, 4
    v_lshl_add_u32 v144, v6, 8, v144
    v_lshl_add_u32 v145, v5, 8, v144
    v_add_u32 v5, 4, v2
    v_mul_u32_u24 v6, 205, v5
    v_lshrrev_b32 v6, 10, v6
    v_mad_u32_u24 v146, v6, s65, v7
    v_mul_u32_u24 v6, 20, v6
    v_lshlrev_b32 v5, 2, v5
    v_sub_u32 v5, v5, v6
    v_bfe_u32 v6, s64, v5, 4
    v_bfe_u32 v5, s66, v5, 4
    v_lshl_add_u32 v146, v6, 8, v146
    v_lshl_add_u32 v147, v5, 8, v146
    v_add_u32 v5, 8, v2
    v_mul_u32_u24 v6, 205, v5
    v_lshrrev_b32 v6, 10, v6
    v_mad_u32_u24 v148, v6, s65, v7
    v_mul_u32_u24 v6, 20, v6
    v_lshlrev_b32 v5, 2, v5
    v_sub_u32 v5, v5, v6
    v_bfe_u32 v6, s64, v5, 4
    v_bfe_u32 v5, s66, v5, 4
    v_lshl_add_u32 v148, v6, 8, v148
    v_lshl_add_u32 v149, v5, 8, v148
    v_add_u32 v5, 12, v2
    v_mul_u32_u24 v6, 205, v5
    v_lshrrev_b32 v6, 10, v6
    v_mad_u32_u24 v150, v6, s65, v7
    v_mul_u32_u24 v6, 20, v6
    v_lshlrev_b32 v5, 2, v5
    v_sub_u32 v5, v5, v6
    v_bfe_u32 v6, s64, v5, 4
    v_bfe_u32 v5, s66, v5, 4
    v_lshl_add_u32 v150, v6, 8, v150
    v_lshl_add_u32 v151, v5, 8, v150
    s_branch L_qkv_c_pro_done
L_qkv_c_vpro:
    s_mul_i32 s67, s62, 5120
    s_add_u32 s67, s67, 8178176
    s_add_u32 s67, s67, s7
    s_sub_u32 s68, s63, 1280
    s_mov_b32 s65, 163520
    v_mul_u32_u24 v2, 320, v4
    v_add_u32 v7, s68, v3
    v_add_u32 v5, 0, v7
    v_mul_u32_u24 v6, 3277, v5
    v_lshrrev_b32 v6, 16, v6
    v_mad_u32_u24 v6, v6, s65, v2
    v_lshl_add_u32 v144, v5, 4, v6
    v_add_u32 v5, 16, v7
    v_mul_u32_u24 v6, 3277, v5
    v_lshrrev_b32 v6, 16, v6
    v_mad_u32_u24 v6, v6, s65, v2
    v_lshl_add_u32 v145, v5, 4, v6
    v_add_u32 v5, 32, v7
    v_mul_u32_u24 v6, 3277, v5
    v_lshrrev_b32 v6, 16, v6
    v_mad_u32_u24 v6, v6, s65, v2
    v_lshl_add_u32 v146, v5, 4, v6
    v_add_u32 v5, 48, v7
    v_mul_u32_u24 v6, 3277, v5
    v_lshrrev_b32 v6, 16, v6
    v_mad_u32_u24 v6, v6, s65, v2
    v_lshl_add_u32 v147, v5, 4, v6
    v_mov_b32 v148, 0
    v_mov_b32 v149, 0
    v_mov_b32 v150, 0
    v_mov_b32 v151, 0
L_qkv_c_pro_done:
    s_lshl_b32 s62, s61, 13
    s_cmp_eq_u32 s7, 0
    s_cbranch_scc1 L_qkv_c_l0
    s_lshl_b32 s46, s34, 4
    s_cmp_lg_u32 s3, 0
    s_cbranch_scc1 Lw0_3
    s_lshl_b32 s44, s46, 2
    s_add_u32 s44, s44, s7
    s_add_u32 s44, s44, -22329344
    v_lshlrev_b32 v164, 2, v1
    s_mov_b32 s45, 0x8000
    s_mov_b64 exec, 0xffff
Lpoll_4:
    buffer_load_dword v160, v164, s[24:27], s44 offen sc1
    s_waitcnt vmcnt(0)
    v_cmp_ne_u32 vcc, s28, v160
    s_sub_u32 s45, s45, 1
    s_cmp_eq_u32 s45, 0
    s_cbranch_scc1 Lpd_5
    s_cmp_lg_u64 vcc, 0
    s_cbranch_scc1 Lpoll_4
Lpd_5:
    s_mov_b64 exec, -1
Lw0_3:
    s_barrier
    v_lshl_add_u32 v136, v1, 4, s62
    v_add_u32 v137, 1024, v136
    s_branch L_qkv_c_go
L_qkv_c_l0:
    v_lshrrev_b32 v5, 1, v3
    v_xor_b32 v5, v5, v4
    v_lshl_add_u32 v6, v3, 7, s62
    v_lshl_add_u32 v136, v5, 4, v6
    v_xor_b32 v137, 64, v136
L_qkv_c_go:
    s_cmp_eq_u32 s35, 15
    s_cbranch_scc1 L_att
    v_lshlrev_b32 v140, 11, v4
    v_bfe_u32 v5, v1, 2, 2
    v_lshl_add_u32 v140, v5, 6, v140
    v_bfe_u32 v5, v1, 4, 1
    v_lshl_add_u32 v140, v5, 5, v140
    v_and_b32 v5, 3, v1
    v_lshl_add_u32 v140, v5, 3, v140
    s_lshl_b32 s62, s60, 9
    s_add_u32 s62, s62, 81920
    v_add_u32 v140, s62, v140
    v_xor_b32 v141, 32, v140
    v_add_u32 v138, 49152, v136
    v_add_u32 v142, 49152, v140
    v_add_u32 v139, 49152, v137
    v_add_u32 v143, 49152, v141
    v_pk_mul_f32 v[8:9], 0, 0
    v_pk_mul_f32 v[10:11], 0, 0
    v_pk_mul_f32 v[12:13], 0, 0
    v_pk_mul_f32 v[14:15], 0, 0
    v_pk_mul_f32 v[16:17], 0, 0
    v_pk_mul_f32 v[18:19], 0, 0
    v_pk_mul_f32 v[20:21], 0, 0
    v_pk_mul_f32 v[22:23], 0, 0
    v_pk_mul_f32 v[24:25], 0, 0
    v_pk_mul_f32 v[26:27], 0, 0
    v_pk_mul_f32 v[28:29], 0, 0
    v_pk_mul_f32 v[30:31], 0, 0
    v_pk_mul_f32 v[32:33], 0, 0
    v_pk_mul_f32 v[34:35], 0, 0
    v_pk_mul_f32 v[36:37], 0, 0
    v_pk_mul_f32 v[38:39], 0, 0
    v_pk_mul_f32 v[40:41], 0, 0
    v_pk_mul_f32 v[42:43], 0, 0
    v_pk_mul_f32 v[44:45], 0, 0
    v_pk_mul_f32 v[46:47], 0, 0
    v_pk_mul_f32 v[48:49], 0, 0
    v_pk_mul_f32 v[50:51], 0, 0
    v_pk_mul_f32 v[52:53], 0, 0
    v_pk_mul_f32 v[54:55], 0, 0
    v_pk_mul_f32 v[56:57], 0, 0
    v_pk_mul_f32 v[58:59], 0, 0
    v_pk_mul_f32 v[60:61], 0, 0
    v_pk_mul_f32 v[62:63], 0, 0
    v_pk_mul_f32 v[64:65], 0, 0
    v_pk_mul_f32 v[66:67], 0, 0
    v_pk_mul_f32 v[68:69], 0, 0
    v_pk_mul_f32 v[70:71], 0, 0
    s_mov_b32 s59, 49152
    v_mov_b32 v217, 0
    v_mov_b32 v218, 0
    v_mov_b32 v154, 0
    s_cmp_lg_u32 s7, 0
    s_cbranch_scc1 Lz_6
    v_and_b32 v5, 31, v1
    v_lshrrev_b32 v6, 5, v1
    v_bfe_u32 v7, v5, 1, 3
    v_xor_b32 v7, v7, v6
    s_lshl_b32 s62, s3, 12
    s_add_u32 s62, s62, 49152
    v_lshl_add_u32 v2, v5, 7, s62
    v_lshl_add_u32 v212, v7, 4, v2
    v_xor_b32 v213, 32, v212
    v_xor_b32 v214, 64, v212
    v_xor_b32 v215, 96, v212
    v_lshlrev_b32 v216, 11, v6
    v_bfe_u32 v2, v1, 2, 2
    v_lshl_add_u32 v216, v2, 6, v216
    v_bfe_u32 v2, v1, 4, 1
    v_xor_b32 v2, v2, v6
    v_lshl_add_u32 v216, v2, 5, v216
    v_and_b32 v2, 3, v1
    v_lshl_add_u32 v216, v2, 3, v216
    s_lshl_b32 s62, s3, 8
    s_add_u32 s62, s62, 131072
    v_add_u32 v216, s62, v216
    v_lshlrev_b32 v217, 3, v5
    v_lshlrev_b32 v218, 4, v5
    v_lshl_add_u32 v218, v6, 3, v218
    s_mov_b32 s68, 0x3f803f80
    v_mov_b32 v208, s68
    v_mov_b32 v209, s68
    v_mov_b32 v210, s68
    v_mov_b32 v211, s68
    s_lshl_b32 s63, s34, 14
    s_lshl_b32 s64, s35, 10
    s_add_u32 s63, s63, s64
    s_lshl_b32 s64, s3, 8
    s_add_u32 s63, s63, s64
    s_add_u32 s63, s63, 51380224
    s_lshl_b32 s64, s35, 15
    s_lshl_b32 s66, s34, 11
    s_add_u32 s64, s64, s66
    s_lshl_b32 s66, s3, 9
    s_add_u32 s64, s64, s66
    s_add_u32 s64, s64, 53248
    v_mov_b32 v154, 0
    s_waitcnt vmcnt(0)
    global_load_dword v155, v154, s[30:31] sc1
Lz_6:
    s_branch L_qkv_c2
S_part:
    ds_read_b128 v[160:163], v212
    ds_read_b128 v[164:167], v213
    ds_read_b128 v[168:171], v214
    ds_read_b128 v[172:175], v215
    ds_read_b64_tr_b16 v[176:177], v216 offset:0
    ds_read_b64_tr_b16 v[178:179], v216 offset:1024
    ds_read_b64_tr_b16 v[180:181], v216 offset:4096
    ds_read_b64_tr_b16 v[182:183], v216 offset:5120
    ds_read_b64_tr_b16 v[184:185], v216 offset:8192
    ds_read_b64_tr_b16 v[186:187], v216 offset:9216
    ds_read_b64_tr_b16 v[188:189], v216 offset:12288
    ds_read_b64_tr_b16 v[190:191], v216 offset:13312
    s_waitcnt lgkmcnt(8)
    v_dot2_f32_bf16 v152, v160, s68, 0
    v_dot2_f32_bf16 v152, v161, s68, v152
    v_dot2_f32_bf16 v152, v162, s68, v152
    v_dot2_f32_bf16 v152, v163, s68, v152
    v_dot2_f32_bf16 v152, v164, s68, v152
    v_dot2_f32_bf16 v152, v165, s68, v152
    v_dot2_f32_bf16 v152, v166, s68, v152
    v_dot2_f32_bf16 v152, v167, s68, v152
    v_dot2_f32_bf16 v152, v168, s68, v152
    v_dot2_f32_bf16 v152, v169, s68, v152
    v_dot2_f32_bf16 v152, v170, s68, v152
    v_dot2_f32_bf16 v152, v171, s68, v152
    v_dot2_f32_bf16 v152, v172, s68, v152
    v_dot2_f32_bf16 v152, v173, s68, v152
    v_dot2_f32_bf16 v152, v174, s68, v152
    v_dot2_f32_bf16 v152, v175, s68, v152
    v_dot2_f32_bf16 v153, v160, v160, 0
    v_dot2_f32_bf16 v153, v161, v161, v153
    v_dot2_f32_bf16 v153, v162, v162, v153
    v_dot2_f32_bf16 v153, v163, v163, v153
    v_dot2_f32_bf16 v153, v164, v164, v153
    v_dot2_f32_bf16 v153, v165, v165, v153
    v_dot2_f32_bf16 v153, v166, v166, v153
    v_dot2_f32_bf16 v153, v167, v167, v153
    v_dot2_f32_bf16 v153, v168, v168, v153
    v_dot2_f32_bf16 v153, v169, v169, v153
    v_dot2_f32_bf16 v153, v170, v170, v153
    v_dot2_f32_bf16 v153, v171, v171, v153
    v_dot2_f32_bf16 v153, v172, v172, v153
    v_dot2_f32_bf16 v153, v173, v173, v153
    v_dot2_f32_bf16 v153, v174, v174, v153
    v_dot2_f32_bf16 v153, v175, v175, v153
    s_waitcnt lgkmcnt(0)
    v_mfma_f32_32x32x16_bf16 v[192:207], v[208:211], v[176:179], 0
    v_mfma_f32_32x32x16_bf16 v[192:207], v[208:211], v[180:183], v[192:207]
    v_mfma_f32_32x32x16_bf16 v[192:207], v[208:211], v[184:187], v[192:207]
    v_mfma_f32_32x32x16_bf16 v[192:207], v[208:211], v[188:191], v[192:207]
    s_waitcnt vmcnt(0)
    v_readfirstlane_b32 s28, v155
    s_nop 1
    s_cmp_lg_u32 s28, 0
    s_cbranch_scc1 L_part_n
    v_mov_b32 v154, 0
    s_mov_b32 s45, 0x8000
Lnn_7:
    global_load_dword v155, v154, s[30:31] sc1
    s_waitcnt vmcnt(0)
    v_readfirstlane_b32 s28, v155
    s_sub_u32 s45, s45, 1
    s_cmp_eq_u32 s45, 0
    s_cbranch_scc1 Lnd_8
    s_cmp_eq_u32 s28, 0
    s_cbranch_scc1 Lnn_7
Lnd_8:
L_part_n:
    v_permlane32_swap_b32 v152, v153
    s_nop 0
    v_add_f32 v152, v152, v153
    v_mov_b32 v153, s28
    buffer_store_dwordx2 v[152:153], v218, s[24:27], s64 offen sc1
    s_nop 6
    v_mov_b32 v193, s28
    s_mov_b32 exec_hi, 0
    buffer_store_dwordx2 v[192:193], v217, s[24:27], s63 offen sc1
    s_mov_b64 exec, -1
    s_setpc_b64 s[32:33]
L_qkv_c2:
    s_cmp_ge_u32 s35, 10
    s_cbranch_scc1 L_qkv_v
    s_lshl_b32 s62, s61, 8
    v_lshl_add_u32 v5, v3, 2, s62
    s_lshl_b32 s62, s60, 8
    v_lshl_add_u32 v6, v4, 4, s62
    s_mov_b32 s58, 9
    s_barrier
    s_cmp_lg_u32 s7, 0
    s_cbranch_scc1 Lz_9
    s_call_b64 s[32:33], S_part
Lz_9:
    ds_read_b64_tr_b16 v[104:105], v142 offset:0
    ds_read_b64_tr_b16 v[106:107], v142 offset:1024
    ds_read_b128 v[72:75], v138 offset:0
    ds_read_b128 v[76:79], v138 offset:2048
    ds_read_b128 v[80:83], v138 offset:4096
    ds_read_b128 v[84:87], v138 offset:6144
    ds_read_b64_tr_b16 v[108:109], v143 offset:0
    ds_read_b64_tr_b16 v[110:111], v143 offset:1024
    ds_read_b64_tr_b16 v[112:113], v142 offset:256
    ds_read_b64_tr_b16 v[114:115], v142 offset:1280
    ds_read_b64_tr_b16 v[116:117], v143 offset:256
    ds_read_b64_tr_b16 v[118:119], v143 offset:1280
.p2align 6
qk_loop:
    s_waitcnt lgkmcnt(0)
    v_mfma_f32_16x16x32_bf16 v[8:11], v[104:107], v[72:75], v[8:11]
    ds_read_b64_tr_b16 v[120:121], v142 offset:8192
    v_mfma_f32_16x16x32_bf16 v[12:15], v[104:107], v[76:79], v[12:15]
    ds_read_b64_tr_b16 v[122:123], v142 offset:9216
    v_mfma_f32_16x16x32_bf16 v[16:19], v[104:107], v[80:83], v[16:19]
    ds_read_b128 v[88:91], v139 offset:0
    v_mfma_f32_16x16x32_bf16 v[20:23], v[104:107], v[84:87], v[20:23]
    ds_read_b128 v[92:95], v139 offset:2048
    v_mfma_f32_16x16x32_bf16 v[36:39], v[108:111], v[84:87], v[36:39]
    ds_read_b128 v[96:99], v139 offset:4096
    v_mfma_f32_16x16x32_bf16 v[32:35], v[108:111], v[80:83], v[32:35]
    ds_read_b128 v[100:103], v139 offset:6144
    v_mfma_f32_16x16x32_bf16 v[28:31], v[108:111], v[76:79], v[28:31]
    ds_read_b64_tr_b16 v[124:125], v143 offset:8192
    v_mfma_f32_16x16x32_bf16 v[24:27], v[108:111], v[72:75], v[24:27]
    ds_read_b64_tr_b16 v[126:127], v143 offset:9216
    v_mfma_f32_16x16x32_bf16 v[40:43], v[112:115], v[72:75], v[40:43]
    ds_read_b64_tr_b16 v[128:129], v142 offset:8448
    v_mfma_f32_16x16x32_bf16 v[44:47], v[112:115], v[76:79], v[44:47]
    ds_read_b64_tr_b16 v[130:131], v142 offset:9472
    v_mfma_f32_16x16x32_bf16 v[48:51], v[112:115], v[80:83], v[48:51]
    ds_read_b64_tr_b16 v[132:133], v143 offset:8448
    v_mfma_f32_16x16x32_bf16 v[52:55], v[112:115], v[84:87], v[52:55]
    ds_read_b64_tr_b16 v[134:135], v143 offset:9472
    v_mfma_f32_16x16x32_bf16 v[68:71], v[116:119], v[84:87], v[68:71]
    s_add_u32 s59, s59, 16384
    s_cmp_eq_u32 s59, 81920
    s_cselect_b32 s59, 0, s59
    v_mfma_f32_16x16x32_bf16 v[64:67], v[116:119], v[80:83], v[64:67]
    v_add_u32 v138, s59, v136
    v_add_u32 v139, s59, v137
    v_mfma_f32_16x16x32_bf16 v[60:63], v[116:119], v[76:79], v[60:63]
    v_add_u32 v142, s59, v140
    v_mfma_f32_16x16x32_bf16 v[56:59], v[116:119], v[72:75], v[56:59]
    v_add_u32 v143, s59, v141
    s_waitcnt lgkmcnt(0)
    v_mfma_f32_16x16x32_bf16 v[8:11], v[120:123], v[88:91], v[8:11]
    s_sub_u32 s58, s58, 1
    s_barrier
    s_cbranch_scc1 qk_tail
    v_mfma_f32_16x16x32_bf16 v[12:15], v[120:123], v[92:95], v[12:15]
    ds_read_b64_tr_b16 v[104:105], v142 offset:0
    v_mfma_f32_16x16x32_bf16 v[16:19], v[120:123], v[96:99], v[16:19]
    ds_read_b64_tr_b16 v[106:107], v142 offset:1024
    v_mfma_f32_16x16x32_bf16 v[20:23], v[120:123], v[100:103], v[20:23]
    ds_read_b128 v[72:75], v138 offset:0
    v_mfma_f32_16x16x32_bf16 v[36:39], v[124:127], v[100:103], v[36:39]
    ds_read_b128 v[76:79], v138 offset:2048
    v_mfma_f32_16x16x32_bf16 v[32:35], v[124:127], v[96:99], v[32:35]
    ds_read_b128 v[80:83], v138 offset:4096
    v_mfma_f32_16x16x32_bf16 v[28:31], v[124:127], v[92:95], v[28:31]
    ds_read_b128 v[84:87], v138 offset:6144
    v_mfma_f32_16x16x32_bf16 v[24:27], v[124:127], v[88:91], v[24:27]
    ds_read_b64_tr_b16 v[108:109], v143 offset:0
    v_mfma_f32_16x16x32_bf16 v[40:43], v[128:131], v[88:91], v[40:43]
    ds_read_b64_tr_b16 v[110:111], v143 offset:1024
    v_mfma_f32_16x16x32_bf16 v[44:47], v[128:131], v[92:95], v[44:47]
    ds_read_b64_tr_b16 v[112:113], v142 offset:256
    v_mfma_f32_16x16x32_bf16 v[48:51], v[128:131], v[96:99], v[48:51]
    ds_read_b64_tr_b16 v[114:115], v142 offset:1280
    v_mfma_f32_16x16x32_bf16 v[52:55], v[128:131], v[100:103], v[52:55]
    ds_read_b64_tr_b16 v[116:117], v143 offset:256
    v_mfma_f32_16x16x32_bf16 v[68:71], v[132:135], v[100:103], v[68:71]
    ds_read_b64_tr_b16 v[118:119], v143 offset:1280
    v_mfma_f32_16x16x32_bf16 v[64:67], v[132:135], v[96:99], v[64:67]
    v_mfma_f32_16x16x32_bf16 v[60:63], v[132:135], v[92:95], v[60:63]
    v_mfma_f32_16x16x32_bf16 v[56:59], v[132:135], v[88:91], v[56:59]
    s_branch qk_loop
qk_tail:
    v_mfma_f32_16x16x32_bf16 v[12:15], v[120:123], v[92:95], v[12:15]
    ds_read2_b32 v[152:153], v5 offset0:0 offset1:128
    v_mfma_f32_16x16x32_bf16 v[16:19], v[120:123], v[96:99], v[16:19]
    ds_read2_b32 v[154:155], v5 offset0:16 offset1:144
    v_mfma_f32_16x16x32_bf16 v[20:23], v[120:123], v[100:103], v[20:23]
    ds_read2_b32 v[156:157], v5 offset0:32 offset1:160
    v_mfma_f32_16x16x32_bf16 v[36:39], v[124:127], v[100:103], v[36:39]
    ds_read2_b32 v[158:159], v5 offset0:48 offset1:176
    v_mfma_f32_16x16x32_bf16 v[32:35], v[124:127], v[96:99], v[32:35]
    ds_read_b128 v[160:163], v6 offset:1024
    v_mfma_f32_16x16x32_bf16 v[28:31], v[124:127], v[92:95], v[28:31]
    ds_read_b128 v[164:167], v6 offset:1088
    v_mfma_f32_16x16x32_bf16 v[24:27], v[124:127], v[88:91], v[24:27]
    ds_read_b128 v[168:171], v6 offset:1152
    v_mfma_f32_16x16x32_bf16 v[40:43], v[128:131], v[88:91], v[40:43]
    ds_read_b128 v[172:175], v6 offset:1216
    v_mfma_f32_16x16x32_bf16 v[44:47], v[128:131], v[92:95], v[44:47]
    v_mfma_f32_16x16x32_bf16 v[48:51], v[128:131], v[96:99], v[48:51]
    v_mfma_f32_16x16x32_bf16 v[52:55], v[128:131], v[100:103], v[52:55]
    v_mfma_f32_16x16x32_bf16 v[68:71], v[132:135], v[100:103], v[68:71]
    v_mfma_f32_16x16x32_bf16 v[64:67], v[132:135], v[96:99], v[64:67]
    v_mfma_f32_16x16x32_bf16 v[60:63], v[132:135], v[92:95], v[60:63]
    v_mfma_f32_16x16x32_bf16 v[56:59], v[132:135], v[88:91], v[56:59]
    s_waitcnt lgkmcnt(0)
    v_mul_f32 v153, s69, v153
    v_mul_f32 v155, s69, v155
    v_mul_f32 v157, s69, v157
    v_mul_f32 v159, s69, v159
    v_pk_fma_f32 v[8:9], v[152:153], v[160:161], v[8:9] op_sel_hi:[0,1,1] neg_lo:[1,0,0] neg_hi:[1,0,0]
    v_pk_fma_f32 v[10:11], v[152:153], v[162:163], v[10:11] op_sel_hi:[0,1,1] neg_lo:[1,0,0] neg_hi:[1,0,0]
    v_pk_mul_f32 v[8:9], v[152:153], v[8:9] op_sel:[1,0] op_sel_hi:[1,1]
    v_pk_mul_f32 v[10:11], v[152:153], v[10:11] op_sel:[1,0] op_sel_hi:[1,1]
    v_cvt_pk_bf16_f32 v8, v8, v9
    v_cvt_pk_bf16_f32 v9, v10, v11
    v_pk_fma_f32 v[12:13], v[154:155], v[160:161], v[12:13] op_sel_hi:[0,1,1] neg_lo:[1,0,0] neg_hi:[1,0,0]
    v_pk_fma_f32 v[14:15], v[154:155], v[162:163], v[14:15] op_sel_hi:[0,1,1] neg_lo:[1,0,0] neg_hi:[1,0,0]
    v_pk_mul_f32 v[12:13], v[154:155], v[12:13] op_sel:[1,0] op_sel_hi:[1,1]
    v_pk_mul_f32 v[14:15], v[154:155], v[14:15] op_sel:[1,0] op_sel_hi:[1,1]
    v_cvt_pk_bf16_f32 v10, v12, v13
    v_cvt_pk_bf16_f32 v11, v14, v15
    buffer_store_dwordx4 v[8:11], v144, s[24:27], s67 offen sc1
    v_pk_fma_f32 v[16:17], v[156:157], v[160:161], v[16:17] op_sel_hi:[0,1,1] neg_lo:[1,0,0] neg_hi:[1,0,0]
    v_pk_fma_f32 v[18:19], v[156:157], v[162:163], v[18:19] op_sel_hi:[0,1,1] neg_lo:[1,0,0] neg_hi:[1,0,0]
    v_pk_mul_f32 v[16:17], v[156:157], v[16:17] op_sel:[1,0] op_sel_hi:[1,1]
    v_pk_mul_f32 v[18:19], v[156:157], v[18:19] op_sel:[1,0] op_sel_hi:[1,1]
    v_cvt_pk_bf16_f32 v16, v16, v17
    v_cvt_pk_bf16_f32 v17, v18, v19
    v_pk_fma_f32 v[20:21], v[158:159], v[160:161], v[20:21] op_sel_hi:[0,1,1] neg_lo:[1,0,0] neg_hi:[1,0,0]
    v_pk_fma_f32 v[22:23], v[158:159], v[162:163], v[22:23] op_sel_hi:[0,1,1] neg_lo:[1,0,0] neg_hi:[1,0,0]
    v_pk_mul_f32 v[20:21], v[158:159], v[20:21] op_sel:[1,0] op_sel_hi:[1,1]
    v_pk_mul_f32 v[22:23], v[158:159], v[22:23] op_sel:[1,0] op_sel_hi:[1,1]
    v_cvt_pk_bf16_f32 v18, v20, v21
    v_cvt_pk_bf16_f32 v19, v22, v23
    buffer_store_dwordx4 v[16:19], v145, s[24:27], s67 offen sc1
    v_pk_fma_f32 v[24:25], v[152:153], v[164:165], v[24:25] op_sel_hi:[0,1,1] neg_lo:[1,0,0] neg_hi:[1,0,0]
    v_pk_fma_f32 v[26:27], v[152:153], v[166:167], v[26:27] op_sel_hi:[0,1,1] neg_lo:[1,0,0] neg_hi:[1,0,0]
    v_pk_mul_f32 v[24:25], v[152:153], v[24:25] op_sel:[1,0] op_sel_hi:[1,1]
    v_pk_mul_f32 v[26:27], v[152:153], v[26:27] op_sel:[1,0] op_sel_hi:[1,1]
    v_cvt_pk_bf16_f32 v24, v24, v25
    v_cvt_pk_bf16_f32 v25, v26, v27
    v_pk_fma_f32 v[28:29], v[154:155], v[164:165], v[28:29] op_sel_hi:[0,1,1] neg_lo:[1,0,0] neg_hi:[1,0,0]
    v_pk_fma_f32 v[30:31], v[154:155], v[166:167], v[30:31] op_sel_hi:[0,1,1] neg_lo:[1,0,0] neg_hi:[1,0,0]
    v_pk_mul_f32 v[28:29], v[154:155], v[28:29] op_sel:[1,0] op_sel_hi:[1,1]
    v_pk_mul_f32 v[30:31], v[154:155], v[30:31] op_sel:[1,0] op_sel_hi:[1,1]
    v_cvt_pk_bf16_f32 v26, v28, v29
    v_cvt_pk_bf16_f32 v27, v30, v31
    buffer_store_dwordx4 v[24:27], v146, s[24:27], s67 offen sc1
    v_pk_fma_f32 v[32:33], v[156:157], v[164:165], v[32:33] op_sel_hi:[0,1,1] neg_lo:[1,0,0] neg_hi:[1,0,0]
    v_pk_fma_f32 v[34:35], v[156:157], v[166:167], v[34:35] op_sel_hi:[0,1,1] neg_lo:[1,0,0] neg_hi:[1,0,0]
    v_pk_mul_f32 v[32:33], v[156:157], v[32:33] op_sel:[1,0] op_sel_hi:[1,1]
    v_pk_mul_f32 v[34:35], v[156:157], v[34:35] op_sel:[1,0] op_sel_hi:[1,1]
    v_cvt_pk_bf16_f32 v32, v32, v33
    v_cvt_pk_bf16_f32 v33, v34, v35
    v_pk_fma_f32 v[36:37], v[158:159], v[164:165], v[36:37] op_sel_hi:[0,1,1] neg_lo:[1,0,0] neg_hi:[1,0,0]
    v_pk_fma_f32 v[38:39], v[158:159], v[166:167], v[38:39] op_sel_hi:[0,1,1] neg_lo:[1,0,0] neg_hi:[1,0,0]
    v_pk_mul_f32 v[36:37], v[158:159], v[36:37] op_sel:[1,0] op_sel_hi:[1,1]
    v_pk_mul_f32 v[38:39], v[158:159], v[38:39] op_sel:[1,0] op_sel_hi:[1,1]
    v_cvt_pk_bf16_f32 v34, v36, v37
    v_cvt_pk_bf16_f32 v35, v38, v39
    buffer_store_dwordx4 v[32:35], v147, s[24:27], s67 offen sc1
    v_pk_fma_f32 v[40:41], v[152:153], v[168:169], v[40:41] op_sel_hi:[0,1,1] neg_lo:[1,0,0] neg_hi:[1,0,0]
    v_pk_fma_f32 v[42:43], v[152:153], v[170:171], v[42:43] op_sel_hi:[0,1,1] neg_lo:[1,0,0] neg_hi:[1,0,0]
    v_pk_mul_f32 v[40:41], v[152:153], v[40:41] op_sel:[1,0] op_sel_hi:[1,1]
    v_pk_mul_f32 v[42:43], v[152:153], v[42:43] op_sel:[1,0] op_sel_hi:[1,1]
    v_cvt_pk_bf16_f32 v40, v40, v41
    v_cvt_pk_bf16_f32 v41, v42, v43
    v_pk_fma_f32 v[44:45], v[154:155], v[168:169], v[44:45] op_sel_hi:[0,1,1] neg_lo:[1,0,0] neg_hi:[1,0,0]
    v_pk_fma_f32 v[46:47], v[154:155], v[170:171], v[46:47] op_sel_hi:[0,1,1] neg_lo:[1,0,0] neg_hi:[1,0,0]
    v_pk_mul_f32 v[44:45], v[154:155], v[44:45] op_sel:[1,0] op_sel_hi:[1,1]
    v_pk_mul_f32 v[46:47], v[154:155], v[46:47] op_sel:[1,0] op_sel_hi:[1,1]
    v_cvt_pk_bf16_f32 v42, v44, v45
    v_cvt_pk_bf16_f32 v43, v46, v47
    buffer_store_dwordx4 v[40:43], v148, s[24:27], s67 offen sc1
    v_pk_fma_f32 v[48:49], v[156:157], v[168:169], v[48:49] op_sel_hi:[0,1,1] neg_lo:[1,0,0] neg_hi:[1,0,0]
    v_pk_fma_f32 v[50:51], v[156:157], v[170:171], v[50:51] op_sel_hi:[0,1,1] neg_lo:[1,0,0] neg_hi:[1,0,0]
    v_pk_mul_f32 v[48:49], v[156:157], v[48:49] op_sel:[1,0] op_sel_hi:[1,1]
    v_pk_mul_f32 v[50:51], v[156:157], v[50:51] op_sel:[1,0] op_sel_hi:[1,1]
    v_cvt_pk_bf16_f32 v48, v48, v49
    v_cvt_pk_bf16_f32 v49, v50, v51
    v_pk_fma_f32 v[52:53], v[158:159], v[168:169], v[52:53] op_sel_hi:[0,1,1] neg_lo:[1,0,0] neg_hi:[1,0,0]
    v_pk_fma_f32 v[54:55], v[158:159], v[170:171], v[54:55] op_sel_hi:[0,1,1] neg_lo:[1,0,0] neg_hi:[1,0,0]
    v_pk_mul_f32 v[52:53], v[158:159], v[52:53] op_sel:[1,0] op_sel_hi:[1,1]
    v_pk_mul_f32 v[54:55], v[158:159], v[54:55] op_sel:[1,0] op_sel_hi:[1,1]
    v_cvt_pk_bf16_f32 v50, v52, v53
    v_cvt_pk_bf16_f32 v51, v54, v55
    buffer_store_dwordx4 v[48:51], v149, s[24:27], s67 offen sc1
    v_pk_fma_f32 v[56:57], v[152:153], v[172:173], v[56:57] op_sel_hi:[0,1,1] neg_lo:[1,0,0] neg_hi:[1,0,0]
    v_pk_fma_f32 v[58:59], v[152:153], v[174:175], v[58:59] op_sel_hi:[0,1,1] neg_lo:[1,0,0] neg_hi:[1,0,0]
    v_pk_mul_f32 v[56:57], v[152:153], v[56:57] op_sel:[1,0] op_sel_hi:[1,1]
    v_pk_mul_f32 v[58:59], v[152:153], v[58:59] op_sel:[1,0] op_sel_hi:[1,1]
    v_cvt_pk_bf16_f32 v56, v56, v57
    v_cvt_pk_bf16_f32 v57, v58, v59
    v_pk_fma_f32 v[60:61], v[154:155], v[172:173], v[60:61] op_sel_hi:[0,1,1] neg_lo:[1,0,0] neg_hi:[1,0,0]
    v_pk_fma_f32 v[62:63], v[154:155], v[174:175], v[62:63] op_sel_hi:[0,1,1] neg_lo:[1,0,0] neg_hi:[1,0,0]
    v_pk_mul_f32 v[60:61], v[154:155], v[60:61] op_sel:[1,0] op_sel_hi:[1,1]
    v_pk_mul_f32 v[62:63], v[154:155], v[62:63] op_sel:[1,0] op_sel_hi:[1,1]
    v_cvt_pk_bf16_f32 v58, v60, v61
    v_cvt_pk_bf16_f32 v59, v62, v63
    buffer_store_dwordx4 v[56:59], v150, s[24:27], s67 offen sc1
    v_pk_fma_f32 v[64:65], v[156:157], v[172:173], v[64:65] op_sel_hi:[0,1,1] neg_lo:[1,0,0] neg_hi:[1,0,0]
    v_pk_fma_f32 v[66:67], v[156:157], v[174:175], v[66:67] op_sel_hi:[0,1,1] neg_lo:[1,0,0] neg_hi:[1,0,0]
    v_pk_mul_f32 v[64:65], v[156:157], v[64:65] op_sel:[1,0] op_sel_hi:[1,1]
    v_pk_mul_f32 v[66:67], v[156:157], v[66:67] op_sel:[1,0] op_sel_hi:[1,1]
    v_cvt_pk_bf16_f32 v64, v64, v65
    v_cvt_pk_bf16_f32 v65, v66, v67
    v_pk_fma_f32 v[68:69], v[158:159], v[172:173], v[68:69] op_sel_hi:[0,1,1] neg_lo:[1,0,0] neg_hi:[1,0,0]
    v_pk_fma_f32 v[70:71], v[158:159], v[174:175], v[70:71] op_sel_hi:[0,1,1] neg_lo:[1,0,0] neg_hi:[1,0,0]
    v_pk_mul_f32 v[68:69], v[158:159], v[68:69] op_sel:[1,0] op_sel_hi:[1,1]
    v_pk_mul_f32 v[70:71], v[158:159], v[70:71] op_sel:[1,0] op_sel_hi:[1,1]
    v_cvt_pk_bf16_f32 v66, v68, v69
    v_cvt_pk_bf16_f32 v67, v70, v71
    buffer_store_dwordx4 v[64:67], v151, s[24:27], s67 offen sc1
    s_branch L_att
L_qkv_v:
    s_lshl_b32 s62, s61, 8
    v_lshl_add_u32 v5, v4, 4, s62
    s_lshl_b32 s62, s60, 8
    s_add_u32 s62, s62, 1024
    v_lshl_add_u32 v6, v3, 2, s62
    s_mov_b32 s58, 9
    s_barrier
    s_cmp_lg_u32 s7, 0
    s_cbranch_scc1 Lz_10
    s_call_b64 s[32:33], S_part
Lz_10:
    ds_read_b64_tr_b16 v[104:105], v142 offset:0
    ds_read_b64_tr_b16 v[106:107], v142 offset:1024
    ds_read_b128 v[72:75], v138 offset:0
    ds_read_b128 v[76:79], v138 offset:2048
    ds_read_b128 v[80:83], v138 offset:4096
    ds_read_b128 v[84:87], v138 offset:6144
    ds_read_b64_tr_b16 v[108:109], v143 offset:0
    ds_read_b64_tr_b16 v[110:111], v143 offset:1024
    ds_read_b64_tr_b16 v[112:113], v142 offset:256
    ds_read_b64_tr_b16 v[114:115], v142 offset:1280
    ds_read_b64_tr_b16 v[116:117], v143 offset:256
    ds_read_b64_tr_b16 v[118:119], v143 offset:1280
.p2align 6
vv_loop:
    s_waitcnt lgkmcnt(0)
    v_mfma_f32_16x16x32_bf16 v[8:11], v[72:75], v[104:107], v[8:11]
    ds_read_b64_tr_b16 v[120:121], v142 offset:8192
    v_mfma_f32_16x16x32_bf16 v[12:15], v[76:79], v[104:107], v[12:15]
    ds_read_b64_tr_b16 v[122:123], v142 offset:9216
    v_mfma_f32_16x16x32_bf16 v[16:19], v[80:83], v[104:107], v[16:19]
    ds_read_b128 v[88:91], v139 offset:0
    v_mfma_f32_16x16x32_bf16 v[20:23], v[84:87], v[104:107], v[20:23]
    ds_read_b128 v[92:95], v139 offset:2048
    v_mfma_f32_16x16x32_bf16 v[36:39], v[84:87], v[108:111], v[36:39]
    ds_read_b128 v[96:99], v139 offset:4096
    v_mfma_f32_16x16x32_bf16 v[32:35], v[80:83], v[108:111], v[32:35]
    ds_read_b128 v[100:103], v139 offset:6144
    v_mfma_f32_16x16x32_bf16 v[28:31], v[76:79], v[108:111], v[28:31]
    ds_read_b64_tr_b16 v[124:125], v143 offset:8192
    v_mfma_f32_16x16x32_bf16 v[24:27], v[72:75], v[108:111], v[24:27]
    ds_read_b64_tr_b16 v[126:127], v143 offset:9216
    v_mfma_f32_16x16x32_bf16 v[40:43], v[72:75], v[112:115], v[40:43]
    ds_read_b64_tr_b16 v[128:129], v142 offset:8448
    v_mfma_f32_16x16x32_bf16 v[44:47], v[76:79], v[112:115], v[44:47]
    ds_read_b64_tr_b16 v[130:131], v142 offset:9472
    v_mfma_f32_16x16x32_bf16 v[48:51], v[80:83], v[112:115], v[48:51]
    ds_read_b64_tr_b16 v[132:133], v143 offset:8448
    v_mfma_f32_16x16x32_bf16 v[52:55], v[84:87], v[112:115], v[52:55]
    ds_read_b64_tr_b16 v[134:135], v143 offset:9472
    v_mfma_f32_16x16x32_bf16 v[68:71], v[84:87], v[116:119], v[68:71]
    s_add_u32 s59, s59, 16384
    s_cmp_eq_u32 s59, 81920
    s_cselect_b32 s59, 0, s59
    v_mfma_f32_16x16x32_bf16 v[64:67], v[80:83], v[116:119], v[64:67]
    v_add_u32 v138, s59, v136
    v_add_u32 v139, s59, v137
    v_mfma_f32_16x16x32_bf16 v[60:63], v[76:79], v[116:119], v[60:63]
    v_add_u32 v142, s59, v140
    v_mfma_f32_16x16x32_bf16 v[56:59], v[72:75], v[116:119], v[56:59]
    v_add_u32 v143, s59, v141
    s_waitcnt lgkmcnt(0)
    v_mfma_f32_16x16x32_bf16 v[8:11], v[88:91], v[120:123], v[8:11]
    s_sub_u32 s58, s58, 1
    s_barrier
    s_cbranch_scc1 vv_tail
    v_mfma_f32_16x16x32_bf16 v[12:15], v[92:95], v[120:123], v[12:15]
    ds_read_b64_tr_b16 v[104:105], v142 offset:0
    v_mfma_f32_16x16x32_bf16 v[16:19], v[96:99], v[120:123], v[16:19]
    ds_read_b64_tr_b16 v[106:107], v142 offset:1024
    v_mfma_f32_16x16x32_bf16 v[20:23], v[100:103], v[120:123], v[20:23]
    ds_read_b128 v[72:75], v138 offset:0
    v_mfma_f32_16x16x32_bf16 v[36:39], v[100:103], v[124:127], v[36:39]
    ds_read_b128 v[76:79], v138 offset:2048
    v_mfma_f32_16x16x32_bf16 v[32:35], v[96:99], v[124:127], v[32:35]
    ds_read_b128 v[80:83], v138 offset:4096
    v_mfma_f32_16x16x32_bf16 v[28:31], v[92:95], v[124:127], v[28:31]
    ds_read_b128 v[84:87], v138 offset:6144
    v_mfma_f32_16x16x32_bf16 v[24:27], v[88:91], v[124:127], v[24:27]
    ds_read_b64_tr_b16 v[108:109], v143 offset:0
    v_mfma_f32_16x16x32_bf16 v[40:43], v[88:91], v[128:131], v[40:43]
    ds_read_b64_tr_b16 v[110:111], v143 offset:1024
    v_mfma_f32_16x16x32_bf16 v[44:47], v[92:95], v[128:131], v[44:47]
    ds_read_b64_tr_b16 v[112:113], v142 offset:256
    v_mfma_f32_16x16x32_bf16 v[48:51], v[96:99], v[128:131], v[48:51]
    ds_read_b64_tr_b16 v[114:115], v142 offset:1280
    v_mfma_f32_16x16x32_bf16 v[52:55], v[100:103], v[128:131], v[52:55]
    ds_read_b64_tr_b16 v[116:117], v143 offset:256
    v_mfma_f32_16x16x32_bf16 v[68:71], v[100:103], v[132:135], v[68:71]
    ds_read_b64_tr_b16 v[118:119], v143 offset:1280
    v_mfma_f32_16x16x32_bf16 v[64:67], v[96:99], v[132:135], v[64:67]
    v_mfma_f32_16x16x32_bf16 v[60:63], v[92:95], v[132:135], v[60:63]
    v_mfma_f32_16x16x32_bf16 v[56:59], v[88:91], v[132:135], v[56:59]
    s_branch vv_loop
vv_tail:
    v_mfma_f32_16x16x32_bf16 v[12:15], v[92:95], v[120:123], v[12:15]
    ds_read2_b32 v[152:153], v6 offset0:0 offset1:16
    v_mfma_f32_16x16x32_bf16 v[16:19], v[96:99], v[120:123], v[16:19]
    ds_read2_b32 v[154:155], v6 offset0:32 offset1:48
    v_mfma_f32_16x16x32_bf16 v[20:23], v[100:103], v[120:123], v[20:23]
    ds_read_b128 v[160:163], v5 offset:0
    v_mfma_f32_16x16x32_bf16 v[36:39], v[100:103], v[124:127], v[36:39]
    ds_read_b128 v[164:167], v5 offset:512
    v_mfma_f32_16x16x32_bf16 v[32:35], v[96:99], v[124:127], v[32:35]
    ds_read_b128 v[168:171], v5 offset:64
    v_mfma_f32_16x16x32_bf16 v[28:31], v[92:95], v[124:127], v[28:31]
    ds_read_b128 v[172:175], v5 offset:576
    v_mfma_f32_16x16x32_bf16 v[24:27], v[88:91], v[124:127], v[24:27]
    ds_read_b128 v[176:179], v5 offset:128
    v_mfma_f32_16x16x32_bf16 v[40:43], v[88:91], v[128:131], v[40:43]
    ds_read_b128 v[180:183], v5 offset:640
    v_mfma_f32_16x16x32_bf16 v[44:47], v[92:95], v[128:131], v[44:47]
    ds_read_b128 v[184:187], v5 offset:192
    v_mfma_f32_16x16x32_bf16 v[48:51], v[96:99], v[128:131], v[48:51]
    ds_read_b128 v[188:191], v5 offset:704
    v_mfma_f32_16x16x32_bf16 v[52:55], v[100:103], v[128:131], v[52:55]
    v_mfma_f32_16x16x32_bf16 v[68:71], v[100:103], v[132:135], v[68:71]
    v_mfma_f32_16x16x32_bf16 v[64:67], v[96:99], v[132:135], v[64:67]
    v_mfma_f32_16x16x32_bf16 v[60:63], v[92:95], v[132:135], v[60:63]
    v_mfma_f32_16x16x32_bf16 v[56:59], v[88:91], v[132:135], v[56:59]
    s_waitcnt lgkmcnt(0)
    v_pk_fma_f32 v[8:9], v[160:161], v[152:153], v[8:9] op_sel_hi:[1,0,1] neg_lo:[1,0,0] neg_hi:[1,0,0]
    v_pk_fma_f32 v[10:11], v[162:163], v[152:153], v[10:11] op_sel_hi:[1,0,1] neg_lo:[1,0,0] neg_hi:[1,0,0]
    v_pk_mul_f32 v[8:9], v[164:165], v[8:9]
    v_pk_mul_f32 v[10:11], v[166:167], v[10:11]
    v_pk_fma_f32 v[12:13], v[168:169], v[152:153], v[12:13] op_sel_hi:[1,0,1] neg_lo:[1,0,0] neg_hi:[1,0,0]
    v_pk_fma_f32 v[14:15], v[170:171], v[152:153], v[14:15] op_sel_hi:[1,0,1] neg_lo:[1,0,0] neg_hi:[1,0,0]
    v_pk_mul_f32 v[12:13], v[172:173], v[12:13]
    v_pk_mul_f32 v[14:15], v[174:175], v[14:15]
    v_cvt_pk_bf16_f32 v8, v8, v12
    v_cvt_pk_bf16_f32 v9, v9, v13
    v_cvt_pk_bf16_f32 v10, v10, v14
    v_cvt_pk_bf16_f32 v11, v11, v15
    buffer_store_dwordx4 v[8:11], v144, s[24:27], s67 offen offset:0 sc1
    v_pk_fma_f32 v[16:17], v[176:177], v[152:153], v[16:17] op_sel_hi:[1,0,1] neg_lo:[1,0,0] neg_hi:[1,0,0]
    v_pk_fma_f32 v[18:19], v[178:179], v[152:153], v[18:19] op_sel_hi:[1,0,1] neg_lo:[1,0,0] neg_hi:[1,0,0]
    v_pk_mul_f32 v[16:17], v[180:181], v[16:17]
    v_pk_mul_f32 v[18:19], v[182:183], v[18:19]
    v_pk_fma_f32 v[20:21], v[184:185], v[152:153], v[20:21] op_sel_hi:[1,0,1] neg_lo:[1,0,0] neg_hi:[1,0,0]
    v_pk_fma_f32 v[22:23], v[186:187], v[152:153], v[22:23] op_sel_hi:[1,0,1] neg_lo:[1,0,0] neg_hi:[1,0,0]
    v_pk_mul_f32 v[20:21], v[188:189], v[20:21]
    v_pk_mul_f32 v[22:23], v[190:191], v[22:23]
    v_cvt_pk_bf16_f32 v16, v16, v20
    v_cvt_pk_bf16_f32 v17, v17, v21
    v_cvt_pk_bf16_f32 v18, v18, v22
    v_cvt_pk_bf16_f32 v19, v19, v23
    buffer_store_dwordx4 v[16:19], v144, s[24:27], s67 offen offset:1280 sc1
    v_pk_fma_f32 v[24:25], v[160:161], v[152:153], v[24:25] op_sel:[0,1,0] op_sel_hi:[1,1,1] neg_lo:[1,0,0] neg_hi:[1,0,0]
    v_pk_fma_f32 v[26:27], v[162:163], v[152:153], v[26:27] op_sel:[0,1,0] op_sel_hi:[1,1,1] neg_lo:[1,0,0] neg_hi:[1,0,0]
    v_pk_mul_f32 v[24:25], v[164:165], v[24:25]
    v_pk_mul_f32 v[26:27], v[166:167], v[26:27]
    v_pk_fma_f32 v[28:29], v[168:169], v[152:153], v[28:29] op_sel:[0,1,0] op_sel_hi:[1,1,1] neg_lo:[1,0,0] neg_hi:[1,0,0]
    v_pk_fma_f32 v[30:31], v[170:171], v[152:153], v[30:31] op_sel:[0,1,0] op_sel_hi:[1,1,1] neg_lo:[1,0,0] neg_hi:[1,0,0]
    v_pk_mul_f32 v[28:29], v[172:173], v[28:29]
    v_pk_mul_f32 v[30:31], v[174:175], v[30:31]
    v_cvt_pk_bf16_f32 v24, v24, v28
    v_cvt_pk_bf16_f32 v25, v25, v29
    v_cvt_pk_bf16_f32 v26, v26, v30
    v_cvt_pk_bf16_f32 v27, v27, v31
    buffer_store_dwordx4 v[24:27], v145, s[24:27], s67 offen offset:0 sc1
    v_pk_fma_f32 v[32:33], v[176:177], v[152:153], v[32:33] op_sel:[0,1,0] op_sel_hi:[1,1,1] neg_lo:[1,0,0] neg_hi:[1,0,0]
    v_pk_fma_f32 v[34:35], v[178:179], v[152:153], v[34:35] op_sel:[0,1,0] op_sel_hi:[1,1,1] neg_lo:[1,0,0] neg_hi:[1,0,0]
    v_pk_mul_f32 v[32:33], v[180:181], v[32:33]
    v_pk_mul_f32 v[34:35], v[182:183], v[34:35]
    v_pk_fma_f32 v[36:37], v[184:185], v[152:153], v[36:37] op_sel:[0,1,0] op_sel_hi:[1,1,1] neg_lo:[1,0,0] neg_hi:[1,0,0]
    v_pk_fma_f32 v[38:39], v[186:187], v[152:153], v[38:39] op_sel:[0,1,0] op_sel_hi:[1,1,1] neg_lo:[1,0,0] neg_hi:[1,0,0]
    v_pk_mul_f32 v[36:37], v[188:189], v[36:37]
    v_pk_mul_f32 v[38:39], v[190:191], v[38:39]
    v_cvt_pk_bf16_f32 v32, v32, v36
    v_cvt_pk_bf16_f32 v33, v33, v37
    v_cvt_pk_bf16_f32 v34, v34, v38
    v_cvt_pk_bf16_f32 v35, v35, v39
    buffer_store_dwordx4 v[32:35], v145, s[24:27], s67 offen offset:1280 sc1
    v_pk_fma_f32 v[40:41], v[160:161], v[154:155], v[40:41] op_sel_hi:[1,0,1] neg_lo:[1,0,0] neg_hi:[1,0,0]
    v_pk_fma_f32 v[42:43], v[162:163], v[154:155], v[42:43] op_sel_hi:[1,0,1] neg_lo:[1,0,0] neg_hi:[1,0,0]
    v_pk_mul_f32 v[40:41], v[164:165], v[40:41]
    v_pk_mul_f32 v[42:43], v[166:167], v[42:43]
    v_pk_fma_f32 v[44:45], v[168:169], v[154:155], v[44:45] op_sel_hi:[1,0,1] neg_lo:[1,0,0] neg_hi:[1,0,0]
    v_pk_fma_f32 v[46:47], v[170:171], v[154:155], v[46:47] op_sel_hi:[1,0,1] neg_lo:[1,0,0] neg_hi:[1,0,0]
    v_pk_mul_f32 v[44:45], v[172:173], v[44:45]
    v_pk_mul_f32 v[46:47], v[174:175], v[46:47]
    v_cvt_pk_bf16_f32 v40, v40, v44
    v_cvt_pk_bf16_f32 v41, v41, v45
    v_cvt_pk_bf16_f32 v42, v42, v46
    v_cvt_pk_bf16_f32 v43, v43, v47
    buffer_store_dwordx4 v[40:43], v146, s[24:27], s67 offen offset:0 sc1
    v_pk_fma_f32 v[48:49], v[176:177], v[154:155], v[48:49] op_sel_hi:[1,0,1] neg_lo:[1,0,0] neg_hi:[1,0,0]
    v_pk_fma_f32 v[50:51], v[178:179], v[154:155], v[50:51] op_sel_hi:[1,0,1] neg_lo:[1,0,0] neg_hi:[1,0,0]
    v_pk_mul_f32 v[48:49], v[180:181], v[48:49]
    v_pk_mul_f32 v[50:51], v[182:183], v[50:51]
    v_pk_fma_f32 v[52:53], v[184:185], v[154:155], v[52:53] op_sel_hi:[1,0,1] neg_lo:[1,0,0] neg_hi:[1,0,0]
    v_pk_fma_f32 v[54:55], v[186:187], v[154:155], v[54:55] op_sel_hi:[1,0,1] neg_lo:[1,0,0] neg_hi:[1,0,0]
    v_pk_mul_f32 v[52:53], v[188:189], v[52:53]
    v_pk_mul_f32 v[54:55], v[190:191], v[54:55]
    v_cvt_pk_bf16_f32 v48, v48, v52
    v_cvt_pk_bf16_f32 v49, v49, v53
    v_cvt_pk_bf16_f32 v50, v50, v54
    v_cvt_pk_bf16_f32 v51, v51, v55
    buffer_store_dwordx4 v[48:51], v146, s[24:27], s67 offen offset:1280 sc1
    v_pk_fma_f32 v[56:57], v[160:161], v[154:155], v[56:57] op_sel:[0,1,0] op_sel_hi:[1,1,1] neg_lo:[1,0,0] neg_hi:[1,0,0]
    v_pk_fma_f32 v[58:59], v[162:163], v[154:155], v[58:59] op_sel:[0,1,0] op_sel_hi:[1,1,1] neg_lo:[1,0,0] neg_hi:[1,0,0]
    v_pk_mul_f32 v[56:57], v[164:165], v[56:57]
    v_pk_mul_f32 v[58:59], v[166:167], v[58:59]
    v_pk_fma_f32 v[60:61], v[168:169], v[154:155], v[60:61] op_sel:[0,1,0] op_sel_hi:[1,1,1] neg_lo:[1,0,0] neg_hi:[1,0,0]
    v_pk_fma_f32 v[62:63], v[170:171], v[154:155], v[62:63] op_sel:[0,1,0] op_sel_hi:[1,1,1] neg_lo:[1,0,0] neg_hi:[1,0,0]
    v_pk_mul_f32 v[60:61], v[172:173], v[60:61]
    v_pk_mul_f32 v[62:63], v[174:175], v[62:63]
    v_cvt_pk_bf16_f32 v56, v56, v60
    v_cvt_pk_bf16_f32 v57, v57, v61
    v_cvt_pk_bf16_f32 v58, v58, v62
    v_cvt_pk_bf16_f32 v59, v59, v63
    buffer_store_dwordx4 v[56:59], v147, s[24:27], s67 offen offset:0 sc1
    v_pk_fma_f32 v[64:65], v[176:177], v[154:155], v[64:65] op_sel:[0,1,0] op_sel_hi:[1,1,1] neg_lo:[1,0,0] neg_hi:[1,0,0]
    v_pk_fma_f32 v[66:67], v[178:179], v[154:155], v[66:67] op_sel:[0,1,0] op_sel_hi:[1,1,1] neg_lo:[1,0,0] neg_hi:[1,0,0]
    v_pk_mul_f32 v[64:65], v[180:181], v[64:65]
    v_pk_mul_f32 v[66:67], v[182:183], v[66:67]
    v_pk_fma_f32 v[68:69], v[184:185], v[154:155], v[68:69] op_sel:[0,1,0] op_sel_hi:[1,1,1] neg_lo:[1,0,0] neg_hi:[1,0,0]
    v_pk_fma_f32 v[70:71], v[186:187], v[154:155], v[70:71] op_sel:[0,1,0] op_sel_hi:[1,1,1] neg_lo:[1,0,0] neg_hi:[1,0,0]
    v_pk_mul_f32 v[68:69], v[188:189], v[68:69]
    v_pk_mul_f32 v[70:71], v[190:191], v[70:71]
    v_cvt_pk_bf16_f32 v64, v64, v68
    v_cvt_pk_bf16_f32 v65, v65, v69
    v_cvt_pk_bf16_f32 v66, v66, v70
    v_cvt_pk_bf16_f32 v67, v67, v71
    buffer_store_dwordx4 v[64:67], v147, s[24:27], s67 offen offset:1280 sc1
    s_branch L_att
L_att:
    s_add_u32 s44, s7, s35
    s_cmp_lg_u32 s44, 15
    s_cbranch_scc1 L_att2
    v_mov_b32 v4, 0
    s_mov_b32 s45, 0x8000
Lnn_11:
    global_load_dword v5, v4, s[30:31] sc1
    s_waitcnt vmcnt(0)
    v_readfirstlane_b32 s28, v5
    s_sub_u32 s45, s45, 1
    s_cmp_eq_u32 s45, 0
    s_cbranch_scc1 Lnd_12
    s_cmp_eq_u32 s28, 0
    s_cbranch_scc1 Lnn_11
Lnd_12:
L_att2:
    s_lshl_b32 s46, s35, 4
    s_add_u32 s46, s46, s34
    s_lshl_b32 s46, s46, 4
    s_getreg_b32 s78, hwreg(HW_REG_XCC_ID)
    s_and_b32 s78, s78, 7
    s_add_u32 s78, s78, s28
    s_mul_i32 s72, s40, 163840
    s_add_u32 s72, s72, s7
    s_add_u32 s72, s72, 8175616
    v_and_b32 v3, 31, v1
    v_lshrrev_b32 v4, 5, v1
    s_cmp_ge_u32 s3, 4
    s_cbranch_scc1 L_att_l
    s_waitcnt vmcnt(0)
    s_barrier
    s_cmp_lg_u32 s3, 0
    s_cbranch_scc1 Lw0_13
    s_lshl_b32 s44, s46, 2
    s_add_u32 s44, s44, s7
    s_add_u32 s44, s44, 16384
    s_mov_b64 exec, 1
    v_mov_b32 v2, s28
    buffer_store_dword v2, off, s[24:27], s44 sc0 sc1
    s_mov_b64 exec, -1
Lw0_13:
    v_lshlrev_b32 v186, 3, v1
    v_mul_u32_u24 v5, 320, v4
    v_lshl_add_u32 v5, v3, 4, v5
    v_add_u32 v187, 2560, v5
    v_mov_b32 v184, v186
    v_mov_b32 v185, v187
    v_lshrrev_b32 v5, 4, v3
    v_lshlrev_b32 v5, 3, v5
    v_and_or_b32 v5, v3, 4, v5
    v_bfe_u32 v6, v3, 3, 1
    v_lshl_add_u32 v5, v6, 1, v5
    v_bfe_u32 v6, v3, 1, 1
    v_add_u32 v5, v5, v6
    v_and_b32 v6, 1, v3
    v_mul_u32_u24 v6, 20480, v6
    v_lshl_add_u32 v189, v5, 3, v6
    v_lshl_add_u32 v188, v5, 4, v6
    v_lshl_add_u32 v188, v4, 8, v188
    s_lshl_b32 s63, s41, 2
    s_add_u32 s63, s63, s6
    s_mul_i32 s60, s63, 81920
    s_lshr_b32 s61, s40, 3
    s_mul_i32 s61, s61, 5120
    s_add_u32 s60, s60, s61
    s_add_u32 s60, s60, s7
    s_add_u32 s60, s60, 13418496
    s_and_b32 s61, s40, 7
    s_lshl_b32 s62, s61, 9
    s_add_u32 s70, s60, s62
    s_lshl_b32 s62, s61, 7
    s_add_u32 s71, s60, s62
    s_add_u32 s71, s71, 4096
    s_add_u32 s74, s70, 40960
    s_add_u32 s75, s71, 40960
    s_mov_b32 s60, 0x01100000
    v_bfe_u32 v5, s60, v3, 1
    s_mov_b32 s60, 0x3f803f80
    v_mul_lo_u32 v5, v5, s60
    v_mov_b32 v152, v5
    v_mov_b32 v153, v5
    v_mov_b32 v154, v5
    v_mov_b32 v155, v5
    v_mov_b32 v156, v5
    v_mov_b32 v157, v5
    v_mov_b32 v158, v5
    v_mov_b32 v159, v5
    v_mov_b32 v160, v5
    v_mov_b32 v161, v5
    v_mov_b32 v162, v5
    v_mov_b32 v163, v5
    v_mov_b32 v164, v5
    v_mov_b32 v165, v5
    v_mov_b32 v166, v5
    v_mov_b32 v167, v5
    v_mov_b32 v168, v5
    v_mov_b32 v169, v5
    v_mov_b32 v170, v5
    v_mov_b32 v171, v5
    v_mov_b32 v172, v5
    v_mov_b32 v173, v5
    v_mov_b32 v174, v5
    v_mov_b32 v175, v5
    v_mov_b32 v176, v5
    v_mov_b32 v177, v5
    v_mov_b32 v178, v5
    v_mov_b32 v179, v5
    v_mov_b32 v180, v5
    v_mov_b32 v181, v5
    v_mov_b32 v182, v5
    v_mov_b32 v183, v5
    v_pk_mul_f32 v[104:105], 0, 0
    v_pk_mul_f32 v[106:107], 0, 0
    v_pk_mul_f32 v[108:109], 0, 0
    v_pk_mul_f32 v[110:111], 0, 0
    v_pk_mul_f32 v[112:113], 0, 0
    v_pk_mul_f32 v[114:115], 0, 0
    v_pk_mul_f32 v[116:117], 0, 0
    v_pk_mul_f32 v[118:119], 0, 0
    v_pk_mul_f32 v[120:121], 0, 0
    v_pk_mul_f32 v[122:123], 0, 0
    v_pk_mul_f32 v[124:125], 0, 0
    v_pk_mul_f32 v[126:127], 0, 0
    v_pk_mul_f32 v[128:129], 0, 0
    v_pk_mul_f32 v[130:131], 0, 0
    v_pk_mul_f32 v[132:133], 0, 0
    v_pk_mul_f32 v[134:135], 0, 0
    v_pk_mul_f32 v[100:101], 0, 0
    v_pk_mul_f32 v[84:85], 0, 0
    v_pk_mul_f32 v[86:87], 0, 0
    s_mul_i32 s60, s40, 81920
    s_mul_i32 s61, s63, 2560
    s_add_u32 s60, s60, s61
    s_add_u32 s60, s60, s7
    s_add_u32 s62, s60, 5554176
    v_lshlrev_b32 v5, 3, v3
    s_mov_b32 s58, 16
    s_mov_b32 s59, 15
    s_setprio 2
    s_mul_i32 s46, s40, 20
    v_mad_u32_u24 v28, v1, 19, s46
    v_lshrrev_b32 v28, 7, v28
    v_lshlrev_b32 v28, 10, v28
    s_lshr_b32 s46, s63, 1
    s_lshl_b32 s46, s46, 4
    s_lshl_b32 s44, s46, 2
    s_add_u32 s44, s44, s7
    s_add_u32 s44, s44, 16384
    s_mov_b32 s45, 0x8000
    s_mov_b64 exec, 0x3
Lpoll_14:
    buffer_load_dword v24, v28, s[24:27], s44 offen sc1
    s_waitcnt vmcnt(0)
    v_cmp_ne_u32 vcc, s28, v24
    s_sub_u32 s45, s45, 1
    s_cmp_eq_u32 s45, 0
    s_cbranch_scc1 Lpd_15
    s_cmp_lg_u64 vcc, 0
    s_cbranch_scc1 Lpoll_14
Lpd_15:
    s_mov_b64 exec, -1
    buffer_load_dwordx2 v[16:17], v5, s[24:27], s62 offen offset:2048 sc1
    buffer_load_dwordx2 v[8:9], v186, s[24:27], s62 offen offset:0 sc1
    buffer_load_dwordx2 v[10:11], v186, s[24:27], s62 offen offset:512 sc1
    buffer_load_dwordx2 v[18:19], v5, s[24:27], s62 offen offset:2304 sc1
    buffer_load_dwordx2 v[12:13], v186, s[24:27], s62 offen offset:1024 sc1
    buffer_load_dwordx2 v[14:15], v186, s[24:27], s62 offen offset:1536 sc1
    s_barrier
    s_barrier
    ds_read_b64 v[20:21], v184 offset:2048
    ds_read2st64_b64 v[136:139], v184 offset0:0 offset1:1
    ds_read2st64_b64 v[140:143], v184 offset0:2 offset1:3
    s_mov_b64 exec, s[42:43]
    ds_read_b128 v[152:155], v185 offset:0
    ds_read_b128 v[156:159], v185 offset:640
    ds_read_b128 v[160:163], v185 offset:1280
    ds_read_b128 v[164:167], v185 offset:1920
    s_mov_b64 exec, -1
    s_waitcnt vmcnt(3) lgkmcnt(4)
    v_mfma_f32_32x32x4_2b_bf16 v[24:55], v[20:21], v[16:17], 0
    s_nop 15
    s_nop 1
    v_mfma_f32_32x32x16_bf16 v[24:39], v[136:139], v[8:11], v[24:39]
    v_mfma_f32_32x32x16_bf16 v[40:55], v[140:143], v[8:11], v[40:55]
    s_waitcnt vmcnt(0) lgkmcnt(0)
    s_nop 9
.p2align 6
L_at_loop:
    v_exp_f32 v24, v24
    v_exp_f32 v25, v25
    v_cvt_pk_bf16_f32 v102, v84, v85
    v_cvt_pk_bf16_f32 v103, v86, v87
    v_exp_f32 v26, v26
    v_exp_f32 v27, v27
    v_mfma_f32_32x32x16_bf16 v[120:135], v[180:183], v[100:103], v[120:135]
    s_mov_b64 exec, s[42:43]
    ds_read_b128 v[168:171], v185 offset:5120
    ds_read_b128 v[172:175], v185 offset:5760
    ds_read_b128 v[176:179], v185 offset:6400
    ds_read_b128 v[180:183], v185 offset:7040
    s_mov_b64 exec, -1
    v_exp_f32 v28, v28
    v_exp_f32 v29, v29
    v_exp_f32 v30, v30
    v_exp_f32 v31, v31
    v_mfma_f32_32x32x4_2b_bf16 v[56:87], v[20:21], v[18:19], 0
    v_exp_f32 v32, v32
    v_exp_f32 v33, v33
    v_cvt_pk_bf16_f32 v88, v24, v25
    v_cvt_pk_bf16_f32 v89, v26, v27
    v_cvt_pk_bf16_f32 v90, v28, v29
    v_cvt_pk_bf16_f32 v91, v30, v31
    v_exp_f32 v34, v34
    v_exp_f32 v35, v35
    v_exp_f32 v36, v36
    v_exp_f32 v37, v37
    v_mfma_f32_32x32x16_bf16 v[104:119], v[152:155], v[88:91], v[104:119]
    ds_read_b64 v[22:23], v184 offset:7168
    ds_read2st64_b64 v[144:147], v184 offset0:10 offset1:11
    ds_read2st64_b64 v[148:151], v184 offset0:12 offset1:13
    v_exp_f32 v38, v38
    v_exp_f32 v39, v39
    v_exp_f32 v40, v40
    v_exp_f32 v41, v41
    v_cvt_pk_bf16_f32 v92, v32, v33
    v_cvt_pk_bf16_f32 v93, v34, v35
    v_exp_f32 v42, v42
    v_exp_f32 v43, v43
    v_cvt_pk_bf16_f32 v94, v36, v37
    v_cvt_pk_bf16_f32 v95, v38, v39
    v_mfma_f32_32x32x16_bf16 v[56:71], v[136:139], v[12:15], v[56:71]
    v_exp_f32 v44, v44
    v_exp_f32 v45, v45
    v_exp_f32 v46, v46
    v_exp_f32 v47, v47
    v_mfma_f32_32x32x16_bf16 v[104:119], v[156:159], v[92:95], v[104:119]
    v_exp_f32 v48, v48
    v_exp_f32 v49, v49
    v_cvt_pk_bf16_f32 v96, v40, v41
    v_cvt_pk_bf16_f32 v97, v42, v43
    v_cvt_pk_bf16_f32 v98, v44, v45
    v_cvt_pk_bf16_f32 v99, v46, v47
    v_exp_f32 v50, v50
    v_exp_f32 v51, v51
    v_mfma_f32_32x32x16_bf16 v[72:87], v[140:143], v[12:15], v[72:87]
    v_exp_f32 v52, v52
    v_exp_f32 v53, v53
    v_cvt_pk_bf16_f32 v100, v48, v49
    v_cvt_pk_bf16_f32 v101, v50, v51
    v_exp_f32 v54, v54
    v_exp_f32 v55, v55
    v_mfma_f32_32x32x16_bf16 v[104:119], v[160:163], v[96:99], v[104:119]
    v_exp_f32 v56, v56
    v_exp_f32 v57, v57
    v_cvt_pk_bf16_f32 v102, v52, v53
    v_cvt_pk_bf16_f32 v103, v54, v55
    v_exp_f32 v58, v58
    v_exp_f32 v59, v59
    v_mfma_f32_32x32x16_bf16 v[104:119], v[164:167], v[100:103], v[104:119]
    s_waitcnt lgkmcnt(0)
    v_exp_f32 v60, v60
    v_exp_f32 v61, v61
    v_exp_f32 v62, v62
    v_exp_f32 v63, v63
    v_mfma_f32_32x32x4_2b_bf16 v[24:55], v[22:23], v[16:17], 0
    v_exp_f32 v64, v64
    v_exp_f32 v65, v65
    v_cvt_pk_bf16_f32 v88, v56, v57
    v_cvt_pk_bf16_f32 v89, v58, v59
    v_cvt_pk_bf16_f32 v90, v60, v61
    v_cvt_pk_bf16_f32 v91, v62, v63
    v_exp_f32 v66, v66
    v_exp_f32 v67, v67
    v_exp_f32 v68, v68
    v_exp_f32 v69, v69
    v_mfma_f32_32x32x16_bf16 v[120:135], v[152:155], v[88:91], v[120:135]
    v_exp_f32 v70, v70
    v_exp_f32 v71, v71
    v_exp_f32 v72, v72
    v_exp_f32 v73, v73
    v_cvt_pk_bf16_f32 v92, v64, v65
    v_cvt_pk_bf16_f32 v93, v66, v67
    v_exp_f32 v74, v74
    v_exp_f32 v75, v75
    v_cvt_pk_bf16_f32 v94, v68, v69
    v_cvt_pk_bf16_f32 v95, v70, v71
    v_mfma_f32_32x32x16_bf16 v[24:39], v[144:147], v[8:11], v[24:39]
    v_exp_f32 v76, v76
    v_exp_f32 v77, v77
    v_exp_f32 v78, v78
    v_exp_f32 v79, v79
    v_mfma_f32_32x32x16_bf16 v[120:135], v[156:159], v[92:95], v[120:135]
    v_exp_f32 v80, v80
    v_exp_f32 v81, v81
    v_cvt_pk_bf16_f32 v96, v72, v73
    v_cvt_pk_bf16_f32 v97, v74, v75
    v_cvt_pk_bf16_f32 v98, v76, v77
    v_cvt_pk_bf16_f32 v99, v78, v79
    v_exp_f32 v82, v82
    v_exp_f32 v83, v83
    v_mfma_f32_32x32x16_bf16 v[40:55], v[148:151], v[8:11], v[40:55]
    v_exp_f32 v84, v84
    v_exp_f32 v85, v85
    v_cvt_pk_bf16_f32 v100, v80, v81
    v_cvt_pk_bf16_f32 v101, v82, v83
    v_exp_f32 v86, v86
    v_exp_f32 v87, v87
    v_mfma_f32_32x32x16_bf16 v[120:135], v[160:163], v[96:99], v[120:135]
    v_exp_f32 v24, v24
    v_exp_f32 v25, v25
    v_cvt_pk_bf16_f32 v102, v84, v85
    v_cvt_pk_bf16_f32 v103, v86, v87
    v_exp_f32 v26, v26
    v_exp_f32 v27, v27
    v_mfma_f32_32x32x16_bf16 v[120:135], v[164:167], v[100:103], v[120:135]
    s_mov_b64 exec, s[42:43]
    ds_read_b128 v[152:155], v185 offset:10240
    ds_read_b128 v[156:159], v185 offset:10880
    ds_read_b128 v[160:163], v185 offset:11520
    ds_read_b128 v[164:167], v185 offset:12160
    s_mov_b64 exec, -1
    v_exp_f32 v28, v28
    v_exp_f32 v29, v29
    v_exp_f32 v30, v30
    v_exp_f32 v31, v31
    v_mfma_f32_32x32x4_2b_bf16 v[56:87], v[22:23], v[18:19], 0
    v_exp_f32 v32, v32
    v_exp_f32 v33, v33
    v_cvt_pk_bf16_f32 v88, v24, v25
    v_cvt_pk_bf16_f32 v89, v26, v27
    v_cvt_pk_bf16_f32 v90, v28, v29
    v_cvt_pk_bf16_f32 v91, v30, v31
    v_exp_f32 v34, v34
    v_exp_f32 v35, v35
    v_exp_f32 v36, v36
    v_exp_f32 v37, v37
    v_mfma_f32_32x32x16_bf16 v[104:119], v[168:171], v[88:91], v[104:119]
    ds_read_b64 v[20:21], v184 offset:12288
    ds_read2st64_b64 v[136:139], v184 offset0:20 offset1:21
    ds_read2st64_b64 v[140:143], v184 offset0:22 offset1:23
    v_exp_f32 v38, v38
    v_exp_f32 v39, v39
    v_exp_f32 v40, v40
    v_exp_f32 v41, v41
    v_cvt_pk_bf16_f32 v92, v32, v33
    v_cvt_pk_bf16_f32 v93, v34, v35
    v_exp_f32 v42, v42
    v_exp_f32 v43, v43
    v_cvt_pk_bf16_f32 v94, v36, v37
    v_cvt_pk_bf16_f32 v95, v38, v39
    v_mfma_f32_32x32x16_bf16 v[56:71], v[144:147], v[12:15], v[56:71]
    v_exp_f32 v44, v44
    v_exp_f32 v45, v45
    v_exp_f32 v46, v46
    v_exp_f32 v47, v47
    v_mfma_f32_32x32x16_bf16 v[104:119], v[172:175], v[92:95], v[104:119]
    v_exp_f32 v48, v48
    v_exp_f32 v49, v49
    v_cvt_pk_bf16_f32 v96, v40, v41
    v_cvt_pk_bf16_f32 v97, v42, v43
    v_cvt_pk_bf16_f32 v98, v44, v45
    v_cvt_pk_bf16_f32 v99, v46, v47
    v_exp_f32 v50, v50
    v_exp_f32 v51, v51
    v_mfma_f32_32x32x16_bf16 v[72:87], v[148:151], v[12:15], v[72:87]
    v_exp_f32 v52, v52
    v_exp_f32 v53, v53
    v_cvt_pk_bf16_f32 v100, v48, v49
    v_cvt_pk_bf16_f32 v101, v50, v51
    v_exp_f32 v54, v54
    v_exp_f32 v55, v55
    v_mfma_f32_32x32x16_bf16 v[104:119], v[176:179], v[96:99], v[104:119]
    v_exp_f32 v56, v56
    v_exp_f32 v57, v57
    v_cvt_pk_bf16_f32 v102, v52, v53
    v_cvt_pk_bf16_f32 v103, v54, v55
    v_exp_f32 v58, v58
    v_exp_f32 v59, v59
    v_mfma_f32_32x32x16_bf16 v[104:119], v[180:183], v[100:103], v[104:119]
    s_waitcnt lgkmcnt(0)
    v_exp_f32 v60, v60
    v_exp_f32 v61, v61
    v_exp_f32 v62, v62
    v_exp_f32 v63, v63
    v_mfma_f32_32x32x4_2b_bf16 v[24:55], v[20:21], v[16:17], 0
    v_exp_f32 v64, v64
    v_exp_f32 v65, v65
    v_cvt_pk_bf16_f32 v88, v56, v57
    v_cvt_pk_bf16_f32 v89, v58, v59
    v_cvt_pk_bf16_f32 v90, v60, v61
    v_cvt_pk_bf16_f32 v91, v62, v63
    v_exp_f32 v66, v66
    v_exp_f32 v67, v67
    v_exp_f32 v68, v68
    v_exp_f32 v69, v69
    v_mfma_f32_32x32x16_bf16 v[120:135], v[168:171], v[88:91], v[120:135]
    v_exp_f32 v70, v70
    v_exp_f32 v71, v71
    v_exp_f32 v72, v72
    v_exp_f32 v73, v73
    v_cvt_pk_bf16_f32 v92, v64, v65
    v_cvt_pk_bf16_f32 v93, v66, v67
    v_exp_f32 v74, v74
    v_exp_f32 v75, v75
    v_cvt_pk_bf16_f32 v94, v68, v69
    v_cvt_pk_bf16_f32 v95, v70, v71
    v_mfma_f32_32x32x16_bf16 v[24:39], v[136:139], v[8:11], v[24:39]
    s_sub_u32 s58, s58, 1
    v_exp_f32 v76, v76
    v_exp_f32 v77, v77
    v_exp_f32 v78, v78
    v_exp_f32 v79, v79
    v_mfma_f32_32x32x16_bf16 v[120:135], v[172:175], v[92:95], v[120:135]
    v_exp_f32 v80, v80
    v_exp_f32 v81, v81
    v_cvt_pk_bf16_f32 v96, v72, v73
    v_cvt_pk_bf16_f32 v97, v74, v75
    v_cvt_pk_bf16_f32 v98, v76, v77
    v_cvt_pk_bf16_f32 v99, v78, v79
    v_exp_f32 v82, v82
    v_exp_f32 v83, v83
    v_mfma_f32_32x32x16_bf16 v[40:55], v[140:143], v[8:11], v[40:55]
    s_cmp_lg_u32 s58, s59
    v_exp_f32 v84, v84
    v_exp_f32 v85, v85
    v_cvt_pk_bf16_f32 v100, v80, v81
    v_cvt_pk_bf16_f32 v101, v82, v83
    v_exp_f32 v86, v86
    v_exp_f32 v87, v87
    v_mfma_f32_32x32x16_bf16 v[120:135], v[176:179], v[96:99], v[120:135]
    s_cbranch_scc0 L_at_hmid
L_at_mid:
    v_exp_f32 v24, v24
    v_exp_f32 v25, v25
    v_cvt_pk_bf16_f32 v102, v84, v85
    v_cvt_pk_bf16_f32 v103, v86, v87
    v_exp_f32 v26, v26
    v_exp_f32 v27, v27
    v_mfma_f32_32x32x16_bf16 v[120:135], v[180:183], v[100:103], v[120:135]
    s_mov_b64 exec, s[42:43]
    ds_read_b128 v[168:171], v185 offset:15360
    ds_read_b128 v[172:175], v185 offset:16000
    ds_read_b128 v[176:179], v185 offset:16640
    ds_read_b128 v[180:183], v185 offset:17280
    s_mov_b64 exec, -1
    v_exp_f32 v28, v28
    v_exp_f32 v29, v29
    v_exp_f32 v30, v30
    v_exp_f32 v31, v31
    v_mfma_f32_32x32x4_2b_bf16 v[56:87], v[20:21], v[18:19], 0
    v_exp_f32 v32, v32
    v_exp_f32 v33, v33
    v_cvt_pk_bf16_f32 v88, v24, v25
    v_cvt_pk_bf16_f32 v89, v26, v27
    v_cvt_pk_bf16_f32 v90, v28, v29
    v_cvt_pk_bf16_f32 v91, v30, v31
    v_exp_f32 v34, v34
    v_exp_f32 v35, v35
    v_exp_f32 v36, v36
    v_exp_f32 v37, v37
    v_mfma_f32_32x32x16_bf16 v[104:119], v[152:155], v[88:91], v[104:119]
    ds_read_b64 v[22:23], v184 offset:17408
    ds_read2st64_b64 v[144:147], v184 offset0:30 offset1:31
    ds_read2st64_b64 v[148:151], v184 offset0:32 offset1:33
    v_exp_f32 v38, v38
    v_exp_f32 v39, v39
    v_exp_f32 v40, v40
    v_exp_f32 v41, v41
    v_cvt_pk_bf16_f32 v92, v32, v33
    v_cvt_pk_bf16_f32 v93, v34, v35
    v_exp_f32 v42, v42
    v_exp_f32 v43, v43
    v_cvt_pk_bf16_f32 v94, v36, v37
    v_cvt_pk_bf16_f32 v95, v38, v39
    v_mfma_f32_32x32x16_bf16 v[56:71], v[136:139], v[12:15], v[56:71]
    v_exp_f32 v44, v44
    v_exp_f32 v45, v45
    v_exp_f32 v46, v46
    v_exp_f32 v47, v47
    v_mfma_f32_32x32x16_bf16 v[104:119], v[156:159], v[92:95], v[104:119]
    v_exp_f32 v48, v48
    v_exp_f32 v49, v49
    v_cvt_pk_bf16_f32 v96, v40, v41
    v_cvt_pk_bf16_f32 v97, v42, v43
    v_cvt_pk_bf16_f32 v98, v44, v45
    v_cvt_pk_bf16_f32 v99, v46, v47
    v_exp_f32 v50, v50
    v_exp_f32 v51, v51
    v_mfma_f32_32x32x16_bf16 v[72:87], v[140:143], v[12:15], v[72:87]
    v_exp_f32 v52, v52
    v_exp_f32 v53, v53
    v_cvt_pk_bf16_f32 v100, v48, v49
    v_cvt_pk_bf16_f32 v101, v50, v51
    v_exp_f32 v54, v54
    v_exp_f32 v55, v55
    v_mfma_f32_32x32x16_bf16 v[104:119], v[160:163], v[96:99], v[104:119]
    v_exp_f32 v56, v56
    v_exp_f32 v57, v57
    v_cvt_pk_bf16_f32 v102, v52, v53
    v_cvt_pk_bf16_f32 v103, v54, v55
    v_exp_f32 v58, v58
    v_exp_f32 v59, v59
    v_mfma_f32_32x32x16_bf16 v[104:119], v[164:167], v[100:103], v[104:119]
    s_waitcnt lgkmcnt(0)
    v_exp_f32 v60, v60
    v_exp_f32 v61, v61
    v_exp_f32 v62, v62
    v_exp_f32 v63, v63
    v_mfma_f32_32x32x4_2b_bf16 v[24:55], v[22:23], v[16:17], 0
    v_exp_f32 v64, v64
    v_exp_f32 v65, v65
    v_cvt_pk_bf16_f32 v88, v56, v57
    v_cvt_pk_bf16_f32 v89, v58, v59
    v_cvt_pk_bf16_f32 v90, v60, v61
    v_cvt_pk_bf16_f32 v91, v62, v63
    v_exp_f32 v66, v66
    v_exp_f32 v67, v67
    v_exp_f32 v68, v68
    v_exp_f32 v69, v69
    v_mfma_f32_32x32x16_bf16 v[120:135], v[152:155], v[88:91], v[120:135]
    v_exp_f32 v70, v70
    v_exp_f32 v71, v71
    v_exp_f32 v72, v72
    v_exp_f32 v73, v73
    v_cvt_pk_bf16_f32 v92, v64, v65
    v_cvt_pk_bf16_f32 v93, v66, v67
    v_exp_f32 v74, v74
    v_exp_f32 v75, v75
    v_cvt_pk_bf16_f32 v94, v68, v69
    v_cvt_pk_bf16_f32 v95, v70, v71
    v_mfma_f32_32x32x16_bf16 v[24:39], v[144:147], v[8:11], v[24:39]
    v_exp_f32 v76, v76
    v_exp_f32 v77, v77
    v_exp_f32 v78, v78
    v_exp_f32 v79, v79
    v_mfma_f32_32x32x16_bf16 v[120:135], v[156:159], v[92:95], v[120:135]
    v_exp_f32 v80, v80
    v_exp_f32 v81, v81
    v_cvt_pk_bf16_f32 v96, v72, v73
    v_cvt_pk_bf16_f32 v97, v74, v75
    v_cvt_pk_bf16_f32 v98, v76, v77
    v_cvt_pk_bf16_f32 v99, v78, v79
    v_exp_f32 v82, v82
    v_exp_f32 v83, v83
    v_mfma_f32_32x32x16_bf16 v[40:55], v[148:151], v[8:11], v[40:55]
    v_exp_f32 v84, v84
    v_exp_f32 v85, v85
    v_cvt_pk_bf16_f32 v100, v80, v81
    v_cvt_pk_bf16_f32 v101, v82, v83
    v_exp_f32 v86, v86
    v_exp_f32 v87, v87
    v_mfma_f32_32x32x16_bf16 v[120:135], v[160:163], v[96:99], v[120:135]
    v_exp_f32 v24, v24
    v_exp_f32 v25, v25
    v_cvt_pk_bf16_f32 v102, v84, v85
    v_cvt_pk_bf16_f32 v103, v86, v87
    v_exp_f32 v26, v26
    v_exp_f32 v27, v27
    v_mfma_f32_32x32x16_bf16 v[120:135], v[164:167], v[100:103], v[120:135]
    s_mov_b64 exec, s[42:43]
    ds_read_b128 v[152:155], v185 offset:20480
    ds_read_b128 v[156:159], v185 offset:21120
    ds_read_b128 v[160:163], v185 offset:21760
    ds_read_b128 v[164:167], v185 offset:22400
    s_mov_b64 exec, -1
    v_exp_f32 v28, v28
    v_exp_f32 v29, v29
    v_exp_f32 v30, v30
    v_exp_f32 v31, v31
    v_mfma_f32_32x32x4_2b_bf16 v[56:87], v[22:23], v[18:19], 0
    v_exp_f32 v32, v32
    v_exp_f32 v33, v33
    v_cvt_pk_bf16_f32 v88, v24, v25
    v_cvt_pk_bf16_f32 v89, v26, v27
    v_cvt_pk_bf16_f32 v90, v28, v29
    v_cvt_pk_bf16_f32 v91, v30, v31
    v_exp_f32 v34, v34
    v_exp_f32 v35, v35
    v_exp_f32 v36, v36
    v_exp_f32 v37, v37
    v_mfma_f32_32x32x16_bf16 v[104:119], v[168:171], v[88:91], v[104:119]
    ds_read_b64 v[20:21], v184 offset:22528
    ds_read2st64_b64 v[136:139], v184 offset0:40 offset1:41
    ds_read2st64_b64 v[140:143], v184 offset0:42 offset1:43
    v_exp_f32 v38, v38
    v_exp_f32 v39, v39
    v_exp_f32 v40, v40
    v_exp_f32 v41, v41
    v_cvt_pk_bf16_f32 v92, v32, v33
    v_cvt_pk_bf16_f32 v93, v34, v35
    v_exp_f32 v42, v42
    v_exp_f32 v43, v43
    v_cvt_pk_bf16_f32 v94, v36, v37
    v_cvt_pk_bf16_f32 v95, v38, v39
    v_mfma_f32_32x32x16_bf16 v[56:71], v[144:147], v[12:15], v[56:71]
    v_exp_f32 v44, v44
    v_exp_f32 v45, v45
    v_exp_f32 v46, v46
    v_exp_f32 v47, v47
    v_mfma_f32_32x32x16_bf16 v[104:119], v[172:175], v[92:95], v[104:119]
    v_exp_f32 v48, v48
    v_exp_f32 v49, v49
    v_cvt_pk_bf16_f32 v96, v40, v41
    v_cvt_pk_bf16_f32 v97, v42, v43
    v_cvt_pk_bf16_f32 v98, v44, v45
    v_cvt_pk_bf16_f32 v99, v46, v47
    v_exp_f32 v50, v50
    v_exp_f32 v51, v51
    v_mfma_f32_32x32x16_bf16 v[72:87], v[148:151], v[12:15], v[72:87]
    v_exp_f32 v52, v52
    v_exp_f32 v53, v53
    v_cvt_pk_bf16_f32 v100, v48, v49
    v_cvt_pk_bf16_f32 v101, v50, v51
    v_exp_f32 v54, v54
    v_exp_f32 v55, v55
    v_mfma_f32_32x32x16_bf16 v[104:119], v[176:179], v[96:99], v[104:119]
    v_exp_f32 v56, v56
    v_exp_f32 v57, v57
    v_cvt_pk_bf16_f32 v102, v52, v53
    v_cvt_pk_bf16_f32 v103, v54, v55
    v_exp_f32 v58, v58
    v_exp_f32 v59, v59
    v_mfma_f32_32x32x16_bf16 v[104:119], v[180:183], v[100:103], v[104:119]
    s_waitcnt lgkmcnt(0)
    v_exp_f32 v60, v60
    v_exp_f32 v61, v61
    v_exp_f32 v62, v62
    v_exp_f32 v63, v63
    v_mfma_f32_32x32x4_2b_bf16 v[24:55], v[20:21], v[16:17], 0
    v_exp_f32 v64, v64
    v_exp_f32 v65, v65
    v_cvt_pk_bf16_f32 v88, v56, v57
    v_cvt_pk_bf16_f32 v89, v58, v59
    v_cvt_pk_bf16_f32 v90, v60, v61
    v_cvt_pk_bf16_f32 v91, v62, v63
    v_exp_f32 v66, v66
    v_exp_f32 v67, v67
    v_exp_f32 v68, v68
    v_exp_f32 v69, v69
    v_mfma_f32_32x32x16_bf16 v[120:135], v[168:171], v[88:91], v[120:135]
    v_exp_f32 v70, v70
    v_exp_f32 v71, v71
    v_exp_f32 v72, v72
    v_exp_f32 v73, v73
    v_cvt_pk_bf16_f32 v92, v64, v65
    v_cvt_pk_bf16_f32 v93, v66, v67
    v_exp_f32 v74, v74
    v_exp_f32 v75, v75
    v_cvt_pk_bf16_f32 v94, v68, v69
    v_cvt_pk_bf16_f32 v95, v70, v71
    v_mfma_f32_32x32x16_bf16 v[24:39], v[136:139], v[8:11], v[24:39]
    s_sub_u32 s58, s58, 1
    v_exp_f32 v76, v76
    v_exp_f32 v77, v77
    v_exp_f32 v78, v78
    v_exp_f32 v79, v79
    v_mfma_f32_32x32x16_bf16 v[120:135], v[172:175], v[92:95], v[120:135]
    v_exp_f32 v80, v80
    v_exp_f32 v81, v81
    v_cvt_pk_bf16_f32 v96, v72, v73
    v_cvt_pk_bf16_f32 v97, v74, v75
    v_cvt_pk_bf16_f32 v98, v76, v77
    v_cvt_pk_bf16_f32 v99, v78, v79
    v_exp_f32 v82, v82
    v_exp_f32 v83, v83
    v_mfma_f32_32x32x16_bf16 v[40:55], v[140:143], v[8:11], v[40:55]
    s_cmp_lg_u32 s58, s59
    v_exp_f32 v84, v84
    v_exp_f32 v85, v85
    v_cvt_pk_bf16_f32 v100, v80, v81
    v_cvt_pk_bf16_f32 v101, v82, v83
    v_add_u32 v184, 20480, v184
    v_add_u32 v185, 20480, v185
    v_exp_f32 v86, v86
    v_exp_f32 v87, v87
    v_mfma_f32_32x32x16_bf16 v[120:135], v[176:179], v[96:99], v[120:135]
    s_cbranch_scc1 L_at_loop
    s_cmp_eq_u32 s58, 0
    s_cbranch_scc1 L_at_done
    s_cmp_eq_u32 s58, 6
    s_cbranch_scc1 L_at_mark
    v_mov_b32 v4, 4096
    s_mov_b32 s45, 0x100000
    s_mov_b32 s59, 6
L_at_c2:
    ds_read_b128 v[192:195], v4
    s_waitcnt lgkmcnt(0)
    v_xor_b32 v5, v192, v193
    v_xor_b32 v6, v194, v195
    v_xor_b32 v7, v192, v194
    v_or3_b32 v5, v5, v6, v7
    v_xor_b32 v6, s28, v192
    v_or_b32 v5, v5, v6
    s_sub_u32 s45, s45, 1
    v_readfirstlane_b32 s60, v5
    s_cbranch_scc1 L_at_loop
    s_cmp_eq_u32 s60, 0
    s_cbranch_scc1 L_at_loop
    s_branch L_at_c2
L_at_mark:
    s_lshl_b32 s60, s3, 2
    v_lshl_add_u32 v190, v1, 10, s60
    v_mov_b32 v191, s28
    s_mov_b64 exec, 15
    ds_write_b32 v190, v191
    s_mov_b64 exec, -1
    s_mov_b32 s59, 0
    s_branch L_at_loop
L_at_hmid:
    s_barrier
    s_mov_b32 s59, 12
    s_branch L_at_mid
L_at_done:
    v_cvt_pk_bf16_f32 v102, v84, v85
    v_cvt_pk_bf16_f32 v103, v86, v87
    s_nop 1
    v_mfma_f32_32x32x16_bf16 v[120:135], v[180:183], v[100:103], v[120:135]
    s_setprio 0
    s_mov_b32 vcc_lo, 0
    s_mov_b32 vcc_hi, -1
    v_cndmask_b32 v58, v116, v112, vcc
    v_rcp_f32 v56, v58
    s_nop 0
    v_pk_mul_f32 v[60:61], v[56:57], v[104:105] op_sel_hi:[0,1]
    v_pk_mul_f32 v[62:63], v[56:57], v[106:107] op_sel_hi:[0,1]
    v_pk_mul_f32 v[64:65], v[56:57], v[108:109] op_sel_hi:[0,1]
    v_pk_mul_f32 v[66:67], v[56:57], v[110:111] op_sel_hi:[0,1]
    v_pk_mul_f32 v[68:69], v[56:57], v[112:113] op_sel_hi:[0,1]
    v_pk_mul_f32 v[70:71], v[56:57], v[114:115] op_sel_hi:[0,1]
    v_cvt_pk_bf16_f32 v136, v60, v61
    v_cvt_pk_bf16_f32 v137, v62, v63
    v_cvt_pk_bf16_f32 v138, v64, v65
    v_cvt_pk_bf16_f32 v139, v66, v67
    v_cvt_pk_bf16_f32 v140, v68, v69
    v_cvt_pk_bf16_f32 v141, v70, v71
    buffer_store_dwordx4 v[136:139], v188, s[24:27], s70 offen sc1
    s_mov_b32 exec_hi, 0
    buffer_store_dwordx2 v[140:141], v189, s[24:27], s71 offen sc1
    s_mov_b64 exec, -1
    v_cndmask_b32 v74, v132, v128, vcc
    v_rcp_f32 v72, v74
    s_nop 0
    v_pk_mul_f32 v[76:77], v[72:73], v[120:121] op_sel_hi:[0,1]
    v_pk_mul_f32 v[78:79], v[72:73], v[122:123] op_sel_hi:[0,1]
    v_pk_mul_f32 v[80:81], v[72:73], v[124:125] op_sel_hi:[0,1]
    v_pk_mul_f32 v[82:83], v[72:73], v[126:127] op_sel_hi:[0,1]
    v_pk_mul_f32 v[84:85], v[72:73], v[128:129] op_sel_hi:[0,1]
    v_pk_mul_f32 v[86:87], v[72:73], v[130:131] op_sel_hi:[0,1]
    v_cvt_pk_bf16_f32 v144, v76, v77
    v_cvt_pk_bf16_f32 v145, v78, v79
    v_cvt_pk_bf16_f32 v146, v80, v81
    v_cvt_pk_bf16_f32 v147, v82, v83
    v_cvt_pk_bf16_f32 v148, v84, v85
    v_cvt_pk_bf16_f32 v149, v86, v87
    buffer_store_dwordx4 v[144:147], v188, s[24:27], s74 offen sc1
    s_mov_b32 exec_hi, 0
    buffer_store_dwordx2 v[148:149], v189, s[24:27], s75 offen sc1
    s_mov_b64 exec, -1
    v_max_f32 v56, abs(v104), abs(v105)
    v_pk_add_f32 v[60:61], v[104:105], v[106:107]
    v_max3_f32 v56, v56, abs(v106), abs(v107)
    v_max3_f32 v56, v56, abs(v108), abs(v109)
    v_max3_f32 v56, v56, abs(v110), abs(v111)
    v_max3_f32 v56, v56, abs(v112), abs(v113)
    v_max3_f32 v56, v56, abs(v114), abs(v115)
    v_max3_f32 v56, v56, abs(v120), abs(v121)
    v_max3_f32 v56, v56, abs(v122), abs(v123)
    v_max3_f32 v56, v56, abs(v124), abs(v125)
    v_max3_f32 v56, v56, abs(v126), abs(v127)
    v_max3_f32 v56, v56, abs(v128), abs(v129)
    v_max3_f32 v56, v56, abs(v130), abs(v131)
    v_pk_add_f32 v[60:61], v[60:61], v[108:109]
    v_pk_add_f32 v[60:61], v[60:61], v[110:111]
    v_pk_add_f32 v[60:61], v[60:61], v[112:113]
    v_pk_add_f32 v[60:61], v[60:61], v[114:115]
    v_pk_add_f32 v[60:61], v[60:61], v[120:121]
    v_pk_add_f32 v[60:61], v[60:61], v[122:123]
    v_pk_add_f32 v[60:61], v[60:61], v[124:125]
    v_pk_add_f32 v[60:61], v[60:61], v[126:127]
    v_pk_add_f32 v[60:61], v[60:61], v[128:129]
    v_pk_add_f32 v[60:61], v[60:61], v[130:131]
    s_mov_b32 s60, 0x37800000
    s_mov_b32 s61, 0x5f800000
    s_mov_b32 s62, 0x7b800000
    v_cmp_le_f32 s[64:65], s60, v58
    v_cmp_ge_f32 s[66:67], s61, v58
    v_cmp_ge_f32 s[68:69], s62, v56
    v_cmp_o_f32 vcc, v60, v61
    s_nop 1
    s_and_b64 s[64:65], s[64:65], s[66:67]
    s_and_b64 s[64:65], s[64:65], s[68:69]
    s_and_b64 s[64:65], s[64:65], vcc
    v_cmp_le_f32 s[66:67], s60, v74
    v_cmp_ge_f32 s[68:69], s61, v74
    s_nop 1
    s_and_b64 s[64:65], s[64:65], s[66:67]
    s_and_b64 s[64:65], s[64:65], s[68:69]
    s_cmp_eq_u64 s[64:65], -1
    s_cbranch_scc0 L_at_slow
L_at_end:
    s_waitcnt vmcnt(0)
    s_barrier
    s_lshl_b32 s46, s41, 5
    s_add_u32 s46, s46, s40
    s_lshl_b32 s46, s46, 4
    s_cmp_lg_u32 s3, 0
    s_cbranch_scc1 Lw0_16
    s_lshl_b32 s44, s46, 2
    s_add_u32 s44, s44, s7
    s_add_u32 s44, s44, 32768
    s_mov_b64 exec, 1
    v_mov_b32 v2, s28
    buffer_store_dword v2, off, s[24:27], s44 sc0 sc1
    s_mov_b64 exec, -1
Lw0_16:
    s_add_u32 s60, s84, s7
    s_add_u32 s60, s60, 2670592
    s_add_u32 s61, s85, s7
    s_add_u32 s61, s61, 5423104
    v_lshlrev_b32 v8, 16, v246
    v_and_b32 v9, 0xffff0000, v246
    v_lshlrev_b32 v10, 16, v247
    v_and_b32 v11, 0xffff0000, v247
    v_lshlrev_b32 v12, 16, v248
    v_and_b32 v13, 0xffff0000, v248
    v_lshlrev_b32 v14, 16, v249
    v_and_b32 v15, 0xffff0000, v249
    v_lshlrev_b32 v16, 16, v250
    v_and_b32 v17, 0xffff0000, v250
    v_lshlrev_b32 v18, 16, v251
    v_and_b32 v19, 0xffff0000, v251
    v_lshlrev_b32 v20, 16, v252
    v_and_b32 v21, 0xffff0000, v252
    v_lshlrev_b32 v22, 16, v253
    v_and_b32 v23, 0xffff0000, v253
    v_lshlrev_b32 v24, 16, v254
    v_and_b32 v25, 0xffff0000, v254
    v_lshlrev_b32 v26, 16, v255
    v_and_b32 v27, 0xffff0000, v255
    v_and_b32 v3, 15, v1
    v_lshrrev_b32 v4, 4, v1
    v_lshlrev_b32 v177, 4, v1
    s_and_b32 s65, s3, 1
    s_lshl_b32 s62, s36, 2
    s_add_u32 s62, s62, s3
    s_mul_i32 s63, s65, 51200
    v_add_u32 v176, s63, v177
    v_lshlrev_b32 v178, 8, v4
    v_lshl_add_u32 v178, v3, 3, v178
    s_mul_i32 s64, s65, 10240
    s_add_u32 s64, s64, s7
    s_add_u32 s64, s64, 13418496
    s_xor_b32 s63, s62, 1
    s_mul_i32 s63, s63, 20480
    s_add_u32 s70, s63, s64
    s_mul_i32 s62, s62, 20480
    s_add_u32 s66, s62, s64
    s_add_u32 s67, s66, 4096
    s_add_u32 s68, s66, 5120
    s_add_u32 s69, s66, 9216
    s_add_u32 s71, s70, 4096
    s_add_u32 s72, s70, 5120
    s_add_u32 s73, s70, 9216
    s_lshr_b32 s46, s36, 2
    s_lshl_b32 s46, s46, 9
    ds_read_b128 v[48:51], v176 offset:0
    ds_read_b128 v[52:55], v176 offset:1024
    ds_read_b128 v[56:59], v176 offset:2048
    ds_read_b128 v[60:63], v176 offset:3072
    ds_read_b128 v[64:67], v176 offset:4096
    s_cmp_lg_u32 s3, 0
    s_cbranch_scc1 Lw0_17
    s_cmp_lg_u32 s7, 0
    s_cbranch_scc1 Lx_18
    s_lshl_b32 s44, s4, 7
    s_add_u32 s44, s44, 3072
    v_lshlrev_b32 v168, 2, v1
    s_mov_b32 exec_hi, 0
    s_mov_b32 s45, 0x8000
Lxc_19:
    buffer_load_dword v169, v168, s[24:27], s44 offen sc1
    s_waitcnt vmcnt(0)
    v_xor_b32 v169, s78, v169
    v_cmp_lt_u32 vcc, 7, v169
    s_sub_u32 s45, s45, 1
    s_cmp_eq_u32 s45, 0
    s_cbranch_scc1 Lxc_20
    s_cmp_lg_u64 vcc, 0
    s_cbranch_scc1 Lxc_19
Lxc_20:
    v_cmp_ne_u32 vcc, 0, v169
    s_mov_b64 exec, -1
    s_nop 0
    s_cmp_eq_u64 vcc, 0
    s_cselect_b32 s29, 1, 0
Lx_18:
    s_lshl_b32 s44, s46, 2
    s_add_u32 s44, s44, s7
    s_add_u32 s44, s44, 32768
    v_lshlrev_b32 v172, 6, v1
    s_mov_b32 s45, 0x8000
    s_mov_b32 exec_hi, 0x0
Lpoll_21:
    buffer_load_dword v168, v172, s[24:27], s44 offen sc1
    s_waitcnt vmcnt(0)
    v_cmp_ne_u32 vcc, s28, v168
    s_sub_u32 s45, s45, 1
    s_cmp_eq_u32 s45, 0
    s_cbranch_scc1 Lpd_22
    s_cmp_lg_u64 vcc, 0
    s_cbranch_scc1 Lpoll_21
Lpd_22:
    s_mov_b64 exec, -1
Lw0_17:
    s_barrier
    buffer_load_dwordx4 v[92:95], v177, s[24:27], s70 offen offset:0 sc1
    buffer_load_dwordx4 v[88:91], v177, s[24:27], s66 offen offset:0 sc1
    buffer_load_dwordx4 v[100:103], v177, s[24:27], s70 offen offset:1024 sc1
    buffer_load_dwordx4 v[96:99], v177, s[24:27], s66 offen offset:1024 sc1
    buffer_load_dwordx4 v[108:111], v177, s[24:27], s70 offen offset:2048 sc1
    buffer_load_dwordx4 v[104:107], v177, s[24:27], s66 offen offset:2048 sc1
    buffer_load_dwordx4 v[116:119], v177, s[24:27], s70 offen offset:3072 sc1
    buffer_load_dwordx4 v[112:115], v177, s[24:27], s66 offen offset:3072 sc1
    buffer_load_dwordx2 v[124:125], v178, s[24:27], s71 offen offset:0 sc1
    buffer_load_dwordx2 v[126:127], v178, s[24:27], s71 offen offset:128 sc1
    buffer_load_dwordx2 v[120:121], v178, s[24:27], s67 offen offset:0 sc1
    buffer_load_dwordx2 v[122:123], v178, s[24:27], s67 offen offset:128 sc1
    s_waitcnt vmcnt(10)
    s_waitcnt lgkmcnt(0)
    v_mfma_f32_16x16x32_bf16 v[28:31], v[48:51], v[92:95], 0
    ds_read_b128 v[68:71], v176 offset:5120
    v_mfma_f32_16x16x32_bf16 v[8:11], v[48:51], v[88:91], v[8:11]
    ds_read_b128 v[72:75], v176 offset:6144
    v_mfma_f32_16x16x32_bf16 v[32:35], v[52:55], v[92:95], 0
    ds_read_b128 v[76:79], v176 offset:7168
    v_mfma_f32_16x16x32_bf16 v[12:15], v[52:55], v[88:91], v[12:15]
    ds_read_b128 v[80:83], v176 offset:8192
    v_mfma_f32_16x16x32_bf16 v[36:39], v[56:59], v[92:95], 0
    ds_read_b128 v[84:87], v176 offset:9216
    v_mfma_f32_16x16x32_bf16 v[16:19], v[56:59], v[88:91], v[16:19]
    buffer_load_dwordx4 v[132:135], v177, s[24:27], s72 offen offset:0 sc1
    v_mfma_f32_16x16x32_bf16 v[40:43], v[60:63], v[92:95], 0
    buffer_load_dwordx4 v[128:131], v177, s[24:27], s68 offen offset:0 sc1
    v_mfma_f32_16x16x32_bf16 v[20:23], v[60:63], v[88:91], v[20:23]
    buffer_load_dwordx4 v[140:143], v177, s[24:27], s72 offen offset:1024 sc1
    v_mfma_f32_16x16x32_bf16 v[44:47], v[64:67], v[92:95], 0
    buffer_load_dwordx4 v[136:139], v177, s[24:27], s68 offen offset:1024 sc1
    v_mfma_f32_16x16x32_bf16 v[24:27], v[64:67], v[88:91], v[24:27]
    s_waitcnt vmcnt(12)
    s_waitcnt lgkmcnt(0)
    v_mfma_f32_16x16x32_bf16 v[28:31], v[68:71], v[100:103], v[28:31]
    ds_read_b128 v[48:51], v176 offset:10240
    v_mfma_f32_16x16x32_bf16 v[8:11], v[68:71], v[96:99], v[8:11]
    ds_read_b128 v[52:55], v176 offset:11264
    v_mfma_f32_16x16x32_bf16 v[32:35], v[72:75], v[100:103], v[32:35]
    ds_read_b128 v[56:59], v176 offset:12288
    v_mfma_f32_16x16x32_bf16 v[12:15], v[72:75], v[96:99], v[12:15]
    ds_read_b128 v[60:63], v176 offset:13312
    v_mfma_f32_16x16x32_bf16 v[36:39], v[76:79], v[100:103], v[36:39]
    ds_read_b128 v[64:67], v176 offset:14336
    v_mfma_f32_16x16x32_bf16 v[16:19], v[76:79], v[96:99], v[16:19]
    buffer_load_dwordx4 v[148:151], v177, s[24:27], s72 offen offset:2048 sc1
    v_mfma_f32_16x16x32_bf16 v[40:43], v[80:83], v[100:103], v[40:43]
    buffer_load_dwordx4 v[144:147], v177, s[24:27], s68 offen offset:2048 sc1
    v_mfma_f32_16x16x32_bf16 v[20:23], v[80:83], v[96:99], v[20:23]
    buffer_load_dwordx4 v[156:159], v177, s[24:27], s72 offen offset:3072 sc1
    v_mfma_f32_16x16x32_bf16 v[44:47], v[84:87], v[100:103], v[44:47]
    buffer_load_dwordx4 v[152:155], v177, s[24:27], s68 offen offset:3072 sc1
    v_mfma_f32_16x16x32_bf16 v[24:27], v[84:87], v[96:99], v[24:27]
    s_waitcnt vmcnt(14)
    s_waitcnt lgkmcnt(0)
    v_mfma_f32_16x16x32_bf16 v[28:31], v[48:51], v[108:111], v[28:31]
    ds_read_b128 v[68:71], v176 offset:15360
    v_mfma_f32_16x16x32_bf16 v[8:11], v[48:51], v[104:107], v[8:11]
    ds_read_b128 v[72:75], v176 offset:16384
    v_mfma_f32_16x16x32_bf16 v[32:35], v[52:55], v[108:111], v[32:35]
    ds_read_b128 v[76:79], v176 offset:17408
    v_mfma_f32_16x16x32_bf16 v[12:15], v[52:55], v[104:107], v[12:15]
    ds_read_b128 v[80:83], v176 offset:18432
    v_mfma_f32_16x16x32_bf16 v[36:39], v[56:59], v[108:111], v[36:39]
    ds_read_b128 v[84:87], v176 offset:19456
    v_mfma_f32_16x16x32_bf16 v[16:19], v[56:59], v[104:107], v[16:19]
    buffer_load_dwordx2 v[164:165], v178, s[24:27], s73 offen offset:0 sc1
    buffer_load_dwordx2 v[166:167], v178, s[24:27], s73 offen offset:128 sc1
    v_mfma_f32_16x16x32_bf16 v[40:43], v[60:63], v[108:111], v[40:43]
    buffer_load_dwordx2 v[160:161], v178, s[24:27], s69 offen offset:0 sc1
    buffer_load_dwordx2 v[162:163], v178, s[24:27], s69 offen offset:128 sc1
    v_mfma_f32_16x16x32_bf16 v[20:23], v[60:63], v[104:107], v[20:23]
    v_mfma_f32_16x16x32_bf16 v[44:47], v[64:67], v[108:111], v[44:47]
    v_mfma_f32_16x16x32_bf16 v[24:27], v[64:67], v[104:107], v[24:27]
    s_waitcnt vmcnt(16)
    s_waitcnt lgkmcnt(0)
    v_mfma_f32_16x16x32_bf16 v[28:31], v[68:71], v[116:119], v[28:31]
    ds_read_b128 v[48:51], v176 offset:20480
    v_mfma_f32_16x16x32_bf16 v[8:11], v[68:71], v[112:115], v[8:11]
    ds_read_b128 v[52:55], v176 offset:21504
    v_mfma_f32_16x16x32_bf16 v[32:35], v[72:75], v[116:119], v[32:35]
    ds_read_b128 v[56:59], v176 offset:22528
    v_mfma_f32_16x16x32_bf16 v[12:15], v[72:75], v[112:115], v[12:15]
    ds_read_b128 v[60:63], v176 offset:23552
    v_mfma_f32_16x16x32_bf16 v[36:39], v[76:79], v[116:119], v[36:39]
    ds_read_b128 v[64:67], v176 offset:24576
    v_mfma_f32_16x16x32_bf16 v[16:19], v[76:79], v[112:115], v[16:19]
    v_mfma_f32_16x16x32_bf16 v[40:43], v[80:83], v[116:119], v[40:43]
    v_mfma_f32_16x16x32_bf16 v[20:23], v[80:83], v[112:115], v[20:23]
    v_mfma_f32_16x16x32_bf16 v[44:47], v[84:87], v[116:119], v[44:47]
    v_mfma_f32_16x16x32_bf16 v[24:27], v[84:87], v[112:115], v[24:27]
    s_waitcnt vmcnt(12)
    s_waitcnt lgkmcnt(0)
    v_mfma_f32_16x16x32_bf16 v[28:31], v[48:51], v[124:127], v[28:31]
    ds_read_b128 v[68:71], v176 offset:25600
    v_mfma_f32_16x16x32_bf16 v[8:11], v[48:51], v[120:123], v[8:11]
    ds_read_b128 v[72:75], v176 offset:26624
    v_mfma_f32_16x16x32_bf16 v[32:35], v[52:55], v[124:127], v[32:35]
    ds_read_b128 v[76:79], v176 offset:27648
    v_mfma_f32_16x16x32_bf16 v[12:15], v[52:55], v[120:123], v[12:15]
    ds_read_b128 v[80:83], v176 offset:28672
    v_mfma_f32_16x16x32_bf16 v[36:39], v[56:59], v[124:127], v[36:39]
    ds_read_b128 v[84:87], v176 offset:29696
    v_mfma_f32_16x16x32_bf16 v[16:19], v[56:59], v[120:123], v[16:19]
    v_mfma_f32_16x16x32_bf16 v[40:43], v[60:63], v[124:127], v[40:43]
    v_mfma_f32_16x16x32_bf16 v[20:23], v[60:63], v[120:123], v[20:23]
    v_mfma_f32_16x16x32_bf16 v[44:47], v[64:67], v[124:127], v[44:47]
    v_mfma_f32_16x16x32_bf16 v[24:27], v[64:67], v[120:123], v[24:27]
    s_waitcnt vmcnt(10)
    s_waitcnt lgkmcnt(0)
    v_mfma_f32_16x16x32_bf16 v[28:31], v[68:71], v[132:135], v[28:31]
    s_barrier
    ds_read_b128 v[48:51], v176 offset:30720
    v_mfma_f32_16x16x32_bf16 v[8:11], v[68:71], v[128:131], v[8:11]
    ds_read_b128 v[52:55], v176 offset:31744
    v_mfma_f32_16x16x32_bf16 v[32:35], v[72:75], v[132:135], v[32:35]
    ds_read_b128 v[56:59], v176 offset:32768
    v_mfma_f32_16x16x32_bf16 v[12:15], v[72:75], v[128:131], v[12:15]
    ds_read_b128 v[60:63], v176 offset:33792
    v_mfma_f32_16x16x32_bf16 v[36:39], v[76:79], v[132:135], v[36:39]
    ds_read_b128 v[64:67], v176 offset:34816
    v_mfma_f32_16x16x32_bf16 v[16:19], v[76:79], v[128:131], v[16:19]
    v_mfma_f32_16x16x32_bf16 v[40:43], v[80:83], v[132:135], v[40:43]
    v_mfma_f32_16x16x32_bf16 v[20:23], v[80:83], v[128:131], v[20:23]
    v_mfma_f32_16x16x32_bf16 v[44:47], v[84:87], v[132:135], v[44:47]
    v_mfma_f32_16x16x32_bf16 v[24:27], v[84:87], v[128:131], v[24:27]
    s_waitcnt vmcnt(8)
    s_waitcnt lgkmcnt(0)
    v_mfma_f32_16x16x32_bf16 v[28:31], v[48:51], v[140:143], v[28:31]
    ds_read_b128 v[68:71], v176 offset:35840
    v_mfma_f32_16x16x32_bf16 v[8:11], v[48:51], v[136:139], v[8:11]
    ds_read_b128 v[72:75], v176 offset:36864
    v_mfma_f32_16x16x32_bf16 v[32:35], v[52:55], v[140:143], v[32:35]
    ds_read_b128 v[76:79], v176 offset:37888
    v_mfma_f32_16x16x32_bf16 v[12:15], v[52:55], v[136:139], v[12:15]
    ds_read_b128 v[80:83], v176 offset:38912
    v_mfma_f32_16x16x32_bf16 v[36:39], v[56:59], v[140:143], v[36:39]
    ds_read_b128 v[84:87], v176 offset:39936
    v_mfma_f32_16x16x32_bf16 v[16:19], v[56:59], v[136:139], v[16:19]
    v_mfma_f32_16x16x32_bf16 v[40:43], v[60:63], v[140:143], v[40:43]
    v_mfma_f32_16x16x32_bf16 v[20:23], v[60:63], v[136:139], v[20:23]
    v_mfma_f32_16x16x32_bf16 v[44:47], v[64:67], v[140:143], v[44:47]
    v_mfma_f32_16x16x32_bf16 v[24:27], v[64:67], v[136:139], v[24:27]
    s_waitcnt vmcnt(6)
    s_waitcnt lgkmcnt(0)
    v_mfma_f32_16x16x32_bf16 v[28:31], v[68:71], v[148:151], v[28:31]
    ds_read_b128 v[48:51], v176 offset:40960
    v_mfma_f32_16x16x32_bf16 v[8:11], v[68:71], v[144:147], v[8:11]
    ds_read_b128 v[52:55], v176 offset:41984
    v_mfma_f32_16x16x32_bf16 v[32:35], v[72:75], v[148:151], v[32:35]
    ds_read_b128 v[56:59], v176 offset:43008
    v_mfma_f32_16x16x32_bf16 v[12:15], v[72:75], v[144:147], v[12:15]
    ds_read_b128 v[60:63], v176 offset:44032
    v_mfma_f32_16x16x32_bf16 v[36:39], v[76:79], v[148:151], v[36:39]
    ds_read_b128 v[64:67], v176 offset:45056
    v_mfma_f32_16x16x32_bf16 v[16:19], v[76:79], v[144:147], v[16:19]
    v_mfma_f32_16x16x32_bf16 v[40:43], v[80:83], v[148:151], v[40:43]
    v_mfma_f32_16x16x32_bf16 v[20:23], v[80:83], v[144:147], v[20:23]
    v_mfma_f32_16x16x32_bf16 v[44:47], v[84:87], v[148:151], v[44:47]
    v_mfma_f32_16x16x32_bf16 v[24:27], v[84:87], v[144:147], v[24:27]
    s_waitcnt vmcnt(4)
    s_waitcnt lgkmcnt(0)
    v_mfma_f32_16x16x32_bf16 v[28:31], v[48:51], v[156:159], v[28:31]
    ds_read_b128 v[68:71], v176 offset:46080
    v_mfma_f32_16x16x32_bf16 v[8:11], v[48:51], v[152:155], v[8:11]
    ds_read_b128 v[72:75], v176 offset:47104
    v_mfma_f32_16x16x32_bf16 v[32:35], v[52:55], v[156:159], v[32:35]
    ds_read_b128 v[76:79], v176 offset:48128
    v_mfma_f32_16x16x32_bf16 v[12:15], v[52:55], v[152:155], v[12:15]
    ds_read_b128 v[80:83], v176 offset:49152
    v_mfma_f32_16x16x32_bf16 v[36:39], v[56:59], v[156:159], v[36:39]
    ds_read_b128 v[84:87], v176 offset:50176
    v_mfma_f32_16x16x32_bf16 v[16:19], v[56:59], v[152:155], v[16:19]
    v_mfma_f32_16x16x32_bf16 v[40:43], v[60:63], v[156:159], v[40:43]
    v_mfma_f32_16x16x32_bf16 v[20:23], v[60:63], v[152:155], v[20:23]
    v_mfma_f32_16x16x32_bf16 v[44:47], v[64:67], v[156:159], v[44:47]
    v_mfma_f32_16x16x32_bf16 v[24:27], v[64:67], v[152:155], v[24:27]
    s_waitcnt vmcnt(0)
    s_waitcnt lgkmcnt(0)
    v_mfma_f32_16x16x32_bf16 v[28:31], v[68:71], v[164:167], v[28:31]
    v_mfma_f32_16x16x32_bf16 v[32:35], v[72:75], v[164:167], v[32:35]
    v_mfma_f32_16x16x32_bf16 v[36:39], v[76:79], v[164:167], v[36:39]
    v_mfma_f32_16x16x32_bf16 v[40:43], v[80:83], v[164:167], v[40:43]
    v_mfma_f32_16x16x32_bf16 v[44:47], v[84:87], v[164:167], v[44:47]
    v_mfma_f32_16x16x32_bf16 v[8:11], v[68:71], v[160:163], v[8:11]
    v_mfma_f32_16x16x32_bf16 v[12:15], v[72:75], v[160:163], v[12:15]
    v_mfma_f32_16x16x32_bf16 v[16:19], v[76:79], v[160:163], v[16:19]
    v_mfma_f32_16x16x32_bf16 v[20:23], v[80:83], v[160:163], v[20:23]
    v_mfma_f32_16x16x32_bf16 v[24:27], v[84:87], v[160:163], v[24:27]
    s_nop 2
    ds_write_b128 v242, v[28:31] offset:0
    ds_write_b128 v242, v[32:35] offset:1024
    ds_write_b128 v242, v[36:39] offset:2048
    ds_write_b128 v242, v[40:43] offset:3072
    ds_write_b128 v242, v[44:47] offset:4096
    s_waitcnt lgkmcnt(0)
    s_barrier
    ds_read_b128 v[28:31], v243 offset:0
    ds_read_b128 v[32:35], v243 offset:1024
    ds_read_b128 v[36:39], v243 offset:2048
    ds_read_b128 v[40:43], v243 offset:3072
    ds_read_b128 v[44:47], v243 offset:4096
    s_waitcnt lgkmcnt(4)
    v_pk_add_f32 v[8:9], v[8:9], v[28:29]
    v_pk_add_f32 v[10:11], v[10:11], v[30:31]
    v_cvt_pk_bf16_f32 v246, v8, v9
    v_cvt_pk_bf16_f32 v247, v10, v11
    buffer_store_dwordx2 v[246:247], v240, s[24:27], s60 offen offset:0
    s_waitcnt lgkmcnt(3)
    v_pk_add_f32 v[12:13], v[12:13], v[32:33]
    v_pk_add_f32 v[14:15], v[14:15], v[34:35]
    v_cvt_pk_bf16_f32 v248, v12, v13
    v_cvt_pk_bf16_f32 v249, v14, v15
    buffer_store_dwordx2 v[248:249], v240, s[24:27], s60 offen offset:512
    s_waitcnt lgkmcnt(2)
    v_pk_add_f32 v[16:17], v[16:17], v[36:37]
    v_pk_add_f32 v[18:19], v[18:19], v[38:39]
    v_cvt_pk_bf16_f32 v250, v16, v17
    v_cvt_pk_bf16_f32 v251, v18, v19
    buffer_store_dwordx2 v[250:251], v240, s[24:27], s60 offen offset:1024
    s_waitcnt lgkmcnt(1)
    v_pk_add_f32 v[20:21], v[20:21], v[40:41]
    v_pk_add_f32 v[22:23], v[22:23], v[42:43]
    v_cvt_pk_bf16_f32 v252, v20, v21
    v_cvt_pk_bf16_f32 v253, v22, v23
    buffer_store_dwordx2 v[252:253], v240, s[24:27], s60 offen offset:1536
    s_waitcnt lgkmcnt(0)
    v_pk_add_f32 v[24:25], v[24:25], v[44:45]
    v_pk_add_f32 v[26:27], v[26:27], v[46:47]
    v_cvt_pk_bf16_f32 v254, v24, v25
    v_cvt_pk_bf16_f32 v255, v26, v27
    buffer_store_dwordx2 v[254:255], v240, s[24:27], s60 offen offset:2048
    v_pk_add_f32 v[168:169], v[8:9], v[10:11]
    v_pk_mul_f32 v[170:171], v[8:9], v[8:9]
    v_pk_fma_f32 v[170:171], v[10:11], v[10:11], v[170:171]
    v_pk_add_f32 v[168:169], v[168:169], v[12:13]
    v_pk_fma_f32 v[170:171], v[12:13], v[12:13], v[170:171]
    v_pk_add_f32 v[168:169], v[168:169], v[14:15]
    v_pk_fma_f32 v[170:171], v[14:15], v[14:15], v[170:171]
    v_pk_add_f32 v[168:169], v[168:169], v[16:17]
    v_pk_fma_f32 v[170:171], v[16:17], v[16:17], v[170:171]
    v_pk_add_f32 v[168:169], v[168:169], v[18:19]
    v_pk_fma_f32 v[170:171], v[18:19], v[18:19], v[170:171]
    v_pk_add_f32 v[168:169], v[168:169], v[20:21]
    v_pk_fma_f32 v[170:171], v[20:21], v[20:21], v[170:171]
    v_pk_add_f32 v[168:169], v[168:169], v[22:23]
    v_pk_fma_f32 v[170:171], v[22:23], v[22:23], v[170:171]
    v_pk_add_f32 v[168:169], v[168:169], v[24:25]
    v_pk_fma_f32 v[170:171], v[24:25], v[24:25], v[170:171]
    v_pk_add_f32 v[168:169], v[168:169], v[26:27]
    v_pk_fma_f32 v[170:171], v[26:27], v[26:27], v[170:171]
    v_add_f32 v168, v168, v169
    v_add_f32 v170, v170, v171
    s_nop 1
    v_permlane32_swap_b32 v168, v170
    s_nop 0
    v_add_f32 v168, v168, v170
    v_mov_b32 v170, v168
    s_nop 1
    v_permlane16_swap_b32 v168, v170
    s_nop 0
    v_add_f32 v168, v168, v170
    buffer_store_dword v168, v241, s[24:27], s61 offen
    s_waitcnt vmcnt(0)
    s_barrier
    s_lshl_b32 s46, s36, 3
    s_add_u32 s46, s46, s37
    s_cmp_lg_u32 s3, 0
    s_cbranch_scc1 Lw0_23
    s_lshl_b32 s44, s46, 2
    s_add_u32 s44, s44, s7
    s_add_u32 s44, s44, 0
    s_mov_b64 exec, 1
    v_mov_b32 v2, s28
    s_cmp_eq_u32 s29, 1
    s_cbranch_scc0 Lsg_24
    buffer_store_dword v2, off, s[24:27], s44
    s_branch Lsg_25
Lsg_24:
    buffer_wbl2 sc1
    s_waitcnt vmcnt(0)
    buffer_store_dword v2, off, s[24:27], s44 sc0 sc1
Lsg_25:
    s_mov_b64 exec, -1
Lw0_23:
    s_and_b32 s60, s3, 1
    s_lshr_b32 s61, s3, 1
    s_lshl_b32 s62, s61, 13
    v_lshl_add_u32 v184, v1, 4, s62
    v_mov_b32 v185, v184
    s_lshl_b32 s62, s60, 13
    v_lshl_add_u32 v186, v1, 4, s62
    v_add_u32 v187, 114688, v186
    s_lshl_b32 s62, s60, 11
    v_lshl_add_u32 v190, v1, 4, s62
    v_add_u32 v188, 4096, v190
    v_add_u32 v189, 114688, v188
    s_mov_b32 s59, 0
    s_mov_b32 s57, 114688
    s_lshl_b32 s46, s38, 4
    s_cmp_lg_u32 s3, 0
    s_cbranch_scc1 Lw0_26
    s_lshl_b32 s44, s46, 2
    s_add_u32 s44, s44, s7
    s_add_u32 s44, s44, 0
    v_lshlrev_b32 v164, 2, v1
    s_mov_b32 s45, 0x8000
    s_mov_b64 exec, 0xffff
Lpoll_27:
    buffer_load_dword v160, v164, s[24:27], s44 offen sc1
    s_waitcnt vmcnt(0)
    v_cmp_ne_u32 vcc, s28, v160
    s_sub_u32 s45, s45, 1
    s_cmp_eq_u32 s45, 0
    s_cbranch_scc1 Lpd_28
    s_cmp_lg_u64 vcc, 0
    s_cbranch_scc1 Lpoll_27
Lpd_28:
    s_mov_b64 exec, -1
Lw0_26:
    s_barrier
    v_pk_mul_f32 v[8:9], 0, 0
    v_pk_mul_f32 v[10:11], 0, 0
    v_pk_mul_f32 v[12:13], 0, 0
    v_pk_mul_f32 v[14:15], 0, 0
    v_pk_mul_f32 v[16:17], 0, 0
    v_pk_mul_f32 v[18:19], 0, 0
    v_pk_mul_f32 v[20:21], 0, 0
    v_pk_mul_f32 v[22:23], 0, 0
    v_pk_mul_f32 v[24:25], 0, 0
    v_pk_mul_f32 v[26:27], 0, 0
    v_pk_mul_f32 v[28:29], 0, 0
    v_pk_mul_f32 v[30:31], 0, 0
    v_pk_mul_f32 v[32:33], 0, 0
    v_pk_mul_f32 v[34:35], 0, 0
    v_pk_mul_f32 v[36:37], 0, 0
    v_pk_mul_f32 v[38:39], 0, 0
    v_pk_mul_f32 v[40:41], 0, 0
    v_pk_mul_f32 v[42:43], 0, 0
    v_pk_mul_f32 v[44:45], 0, 0
    v_pk_mul_f32 v[46:47], 0, 0
    v_pk_mul_f32 v[48:49], 0, 0
    v_pk_mul_f32 v[50:51], 0, 0
    v_pk_mul_f32 v[52:53], 0, 0
    v_pk_mul_f32 v[54:55], 0, 0
    v_pk_mul_f32 v[56:57], 0, 0
    v_pk_mul_f32 v[58:59], 0, 0
    v_pk_mul_f32 v[60:61], 0, 0
    v_pk_mul_f32 v[62:63], 0, 0
    v_pk_mul_f32 v[64:65], 0, 0
    v_pk_mul_f32 v[66:67], 0, 0
    v_pk_mul_f32 v[68:69], 0, 0
    v_pk_mul_f32 v[70:71], 0, 0
    v_pk_mul_f32 v[72:73], 0, 0
    v_pk_mul_f32 v[74:75], 0, 0
    v_pk_mul_f32 v[76:77], 0, 0
    v_pk_mul_f32 v[78:79], 0, 0
    v_pk_mul_f32 v[80:81], 0, 0
    v_pk_mul_f32 v[82:83], 0, 0
    v_pk_mul_f32 v[84:85], 0, 0
    v_pk_mul_f32 v[86:87], 0, 0
    v_pk_mul_f32 v[88:89], 0, 0
    v_pk_mul_f32 v[90:91], 0, 0
    v_pk_mul_f32 v[92:93], 0, 0
    v_pk_mul_f32 v[94:95], 0, 0
    v_pk_mul_f32 v[96:97], 0, 0
    v_pk_mul_f32 v[98:99], 0, 0
    v_pk_mul_f32 v[100:101], 0, 0
    v_pk_mul_f32 v[102:103], 0, 0
    s_lshl_b32 s62, s60, 9
    s_add_u32 s62, s62, 1024
    v_and_b32 v3, 15, v1
    v_lshl_add_u32 v191, v3, 4, s62
    v_lshrrev_b32 v3, 5, v1
    v_lshl_add_u32 v191, v3, 8, v191
    v_bfe_u32 v3, v1, 4, 1
    v_mul_u32_u24 v3, 49152, v3
    v_add_u32 v191, v191, v3
    s_lshl_b32 s62, s38, 1
    s_add_u32 s62, s62, s61
    s_mul_i32 s64, s62, 196608
    s_mul_i32 s63, s39, 3072
    s_add_u32 s64, s64, s63
    s_add_u32 s64, s64, s7
    s_add_u32 s64, s64, 16039936
    s_add_u32 s65, s64, 49152
    s_add_u32 s66, s64, 98304
    s_add_u32 s67, s64, 147456
    v_and_b32 v3, 15, v1
    v_and_b32 v4, 48, v1
    s_lshl_b32 s62, s61, 8
    s_add_u32 s62, s62, 32768
    v_lshl_add_u32 v5, v3, 2, s62
    s_lshl_b32 s62, s60, 9
    v_add_u32 v6, s62, v4
    s_lshl_b32 s62, s60, 7
    v_add_u32 v7, s62, v4
    s_mov_b32 s58, 9
    s_barrier
    ds_read_b128 v[120:123], v189 offset:0
    ds_read_b128 v[104:107], v185 offset:0
    ds_read_b128 v[108:111], v185 offset:2048
    ds_read_b128 v[112:115], v185 offset:4096
    ds_read_b128 v[116:119], v185 offset:6144
    ds_read_b128 v[124:127], v189 offset:1024
    ds_read_b128 v[128:131], v187 offset:0
    ds_read_b128 v[132:135], v187 offset:1024
    ds_read_b128 v[136:139], v187 offset:2048
    ds_read_b128 v[140:143], v187 offset:3072
.p2align 6
gu_loop:
    s_waitcnt lgkmcnt(0)
    v_mfma_f32_16x16x32_bf16 v[8:11], v[120:123], v[104:107], v[8:11]
    ds_read_b128 v[160:163], v189 offset:12288
    v_mfma_f32_16x16x32_bf16 v[12:15], v[120:123], v[108:111], v[12:15]
    ds_read_b128 v[144:147], v185 offset:1024
    v_mfma_f32_16x16x32_bf16 v[16:19], v[120:123], v[112:115], v[16:19]
    ds_read_b128 v[148:151], v185 offset:3072
    v_mfma_f32_16x16x32_bf16 v[20:23], v[120:123], v[116:119], v[20:23]
    ds_read_b128 v[152:155], v185 offset:5120
    v_mfma_f32_16x16x32_bf16 v[36:39], v[124:127], v[116:119], v[36:39]
    ds_read_b128 v[156:159], v185 offset:7168
    v_mfma_f32_16x16x32_bf16 v[32:35], v[124:127], v[112:115], v[32:35]
    ds_read_b128 v[164:167], v189 offset:13312
    v_mfma_f32_16x16x32_bf16 v[28:31], v[124:127], v[108:111], v[28:31]
    ds_read_b128 v[168:171], v187 offset:12288
    v_mfma_f32_16x16x32_bf16 v[24:27], v[124:127], v[104:107], v[24:27]
    ds_read_b128 v[172:175], v187 offset:13312
    v_mfma_f32_16x16x32_bf16 v[40:43], v[128:131], v[104:107], v[40:43]
    ds_read_b128 v[176:179], v187 offset:14336
    v_mfma_f32_16x16x32_bf16 v[44:47], v[128:131], v[108:111], v[44:47]
    ds_read_b128 v[180:183], v187 offset:15360
    v_mfma_f32_16x16x32_bf16 v[48:51], v[128:131], v[112:115], v[48:51]
    s_add_u32 s59, s59, 16384
    s_cmp_eq_u32 s59, 65536
    v_mfma_f32_16x16x32_bf16 v[52:55], v[128:131], v[116:119], v[52:55]
    s_cselect_b32 s59, 0, s59
    s_add_u32 s57, s57, 24576
    v_mfma_f32_16x16x32_bf16 v[68:71], v[132:135], v[116:119], v[68:71]
    s_cmp_eq_u32 s57, 163840
    s_cselect_b32 s57, 65536, s57
    v_mfma_f32_16x16x32_bf16 v[64:67], v[132:135], v[112:115], v[64:67]
    v_add_u32 v185, s59, v184
    v_mfma_f32_16x16x32_bf16 v[60:63], v[132:135], v[108:111], v[60:63]
    v_add_u32 v187, s57, v186
    v_mfma_f32_16x16x32_bf16 v[56:59], v[132:135], v[104:107], v[56:59]
    v_add_u32 v189, s57, v188
    v_mfma_f32_16x16x32_bf16 v[72:75], v[136:139], v[104:107], v[72:75]
    v_mfma_f32_16x16x32_bf16 v[76:79], v[136:139], v[108:111], v[76:79]
    v_mfma_f32_16x16x32_bf16 v[80:83], v[136:139], v[112:115], v[80:83]
    v_mfma_f32_16x16x32_bf16 v[84:87], v[136:139], v[116:119], v[84:87]
    v_mfma_f32_16x16x32_bf16 v[100:103], v[140:143], v[116:119], v[100:103]
    v_mfma_f32_16x16x32_bf16 v[96:99], v[140:143], v[112:115], v[96:99]
    v_mfma_f32_16x16x32_bf16 v[92:95], v[140:143], v[108:111], v[92:95]
    v_mfma_f32_16x16x32_bf16 v[88:91], v[140:143], v[104:107], v[88:91]
    s_waitcnt lgkmcnt(0)
    v_mfma_f32_16x16x32_bf16 v[8:11], v[160:163], v[144:147], v[8:11]
    s_sub_u32 s58, s58, 1
    s_barrier
    s_cbranch_scc1 gu_tail
    v_mfma_f32_16x16x32_bf16 v[12:15], v[160:163], v[148:151], v[12:15]
    ds_read_b128 v[120:123], v189 offset:0
    v_mfma_f32_16x16x32_bf16 v[16:19], v[160:163], v[152:155], v[16:19]
    ds_read_b128 v[104:107], v185 offset:0
    v_mfma_f32_16x16x32_bf16 v[20:23], v[160:163], v[156:159], v[20:23]
    ds_read_b128 v[108:111], v185 offset:2048
    v_mfma_f32_16x16x32_bf16 v[36:39], v[164:167], v[156:159], v[36:39]
    ds_read_b128 v[112:115], v185 offset:4096
    v_mfma_f32_16x16x32_bf16 v[32:35], v[164:167], v[152:155], v[32:35]
    ds_read_b128 v[116:119], v185 offset:6144
    v_mfma_f32_16x16x32_bf16 v[28:31], v[164:167], v[148:151], v[28:31]
    ds_read_b128 v[124:127], v189 offset:1024
    v_mfma_f32_16x16x32_bf16 v[24:27], v[164:167], v[144:147], v[24:27]
    ds_read_b128 v[128:131], v187 offset:0
    v_mfma_f32_16x16x32_bf16 v[40:43], v[168:171], v[144:147], v[40:43]
    ds_read_b128 v[132:135], v187 offset:1024
    v_mfma_f32_16x16x32_bf16 v[44:47], v[168:171], v[148:151], v[44:47]
    ds_read_b128 v[136:139], v187 offset:2048
    v_mfma_f32_16x16x32_bf16 v[48:51], v[168:171], v[152:155], v[48:51]
    ds_read_b128 v[140:143], v187 offset:3072
    v_mfma_f32_16x16x32_bf16 v[52:55], v[168:171], v[156:159], v[52:55]
    v_mfma_f32_16x16x32_bf16 v[68:71], v[172:175], v[156:159], v[68:71]
    v_mfma_f32_16x16x32_bf16 v[64:67], v[172:175], v[152:155], v[64:67]
    v_mfma_f32_16x16x32_bf16 v[60:63], v[172:175], v[148:151], v[60:63]
    v_mfma_f32_16x16x32_bf16 v[56:59], v[172:175], v[144:147], v[56:59]
    v_mfma_f32_16x16x32_bf16 v[72:75], v[176:179], v[144:147], v[72:75]
    v_mfma_f32_16x16x32_bf16 v[76:79], v[176:179], v[148:151], v[76:79]
    v_mfma_f32_16x16x32_bf16 v[80:83], v[176:179], v[152:155], v[80:83]
    v_mfma_f32_16x16x32_bf16 v[84:87], v[176:179], v[156:159], v[84:87]
    v_mfma_f32_16x16x32_bf16 v[100:103], v[180:183], v[156:159], v[100:103]
    v_mfma_f32_16x16x32_bf16 v[96:99], v[180:183], v[152:155], v[96:99]
    v_mfma_f32_16x16x32_bf16 v[92:95], v[180:183], v[148:151], v[92:95]
    v_mfma_f32_16x16x32_bf16 v[88:91], v[180:183], v[144:147], v[88:91]
    s_branch gu_loop
gu_tail:
    v_mfma_f32_16x16x32_bf16 v[12:15], v[160:163], v[148:151], v[12:15]
    ds_read2_b32 v[104:105], v5 offset0:0 offset1:128
    v_mfma_f32_16x16x32_bf16 v[16:19], v[160:163], v[152:155], v[16:19]
    ds_read2_b32 v[106:107], v5 offset0:16 offset1:144
    v_mfma_f32_16x16x32_bf16 v[20:23], v[160:163], v[156:159], v[20:23]
    ds_read2_b32 v[108:109], v5 offset0:32 offset1:160
    v_mfma_f32_16x16x32_bf16 v[36:39], v[164:167], v[156:159], v[36:39]
    ds_read2_b32 v[110:111], v5 offset0:48 offset1:176
    v_mfma_f32_16x16x32_bf16 v[32:35], v[164:167], v[152:155], v[32:35]
    ds_read_b128 v[120:123], v7 offset:34048
    v_mfma_f32_16x16x32_bf16 v[28:31], v[164:167], v[148:151], v[28:31]
    ds_read_b128 v[124:127], v7 offset:34112
    v_mfma_f32_16x16x32_bf16 v[24:27], v[164:167], v[144:147], v[24:27]
    ds_read_b128 v[128:131], v6 offset:33792
    v_mfma_f32_16x16x32_bf16 v[40:43], v[168:171], v[144:147], v[40:43]
    ds_read_b128 v[132:135], v6 offset:33856
    v_mfma_f32_16x16x32_bf16 v[44:47], v[168:171], v[148:151], v[44:47]
    ds_read_b128 v[136:139], v6 offset:33920
    v_mfma_f32_16x16x32_bf16 v[48:51], v[168:171], v[152:155], v[48:51]
    ds_read_b128 v[140:143], v6 offset:33984
    v_mfma_f32_16x16x32_bf16 v[52:55], v[168:171], v[156:159], v[52:55]
    v_mfma_f32_16x16x32_bf16 v[68:71], v[172:175], v[156:159], v[68:71]
    v_mfma_f32_16x16x32_bf16 v[64:67], v[172:175], v[152:155], v[64:67]
    v_mfma_f32_16x16x32_bf16 v[60:63], v[172:175], v[148:151], v[60:63]
    v_mfma_f32_16x16x32_bf16 v[56:59], v[172:175], v[144:147], v[56:59]
    v_mfma_f32_16x16x32_bf16 v[72:75], v[176:179], v[144:147], v[72:75]
    v_mfma_f32_16x16x32_bf16 v[76:79], v[176:179], v[148:151], v[76:79]
    v_mfma_f32_16x16x32_bf16 v[80:83], v[176:179], v[152:155], v[80:83]
    v_mfma_f32_16x16x32_bf16 v[84:87], v[176:179], v[156:159], v[84:87]
    v_mfma_f32_16x16x32_bf16 v[100:103], v[180:183], v[156:159], v[100:103]
    v_mfma_f32_16x16x32_bf16 v[96:99], v[180:183], v[152:155], v[96:99]
    v_mfma_f32_16x16x32_bf16 v[92:95], v[180:183], v[148:151], v[92:95]
    v_mfma_f32_16x16x32_bf16 v[88:91], v[180:183], v[144:147], v[88:91]
    s_waitcnt lgkmcnt(0)
    v_mul_f32 v105, v105, v105
    v_mul_f32 v107, v107, v107
    v_mul_f32 v109, v109, v109
    v_mul_f32 v111, v111, v111
    v_pk_fma_f32 v[8:9], v[104:105], v[120:121], v[8:9] op_sel_hi:[0,1,1] neg_lo:[1,0,0] neg_hi:[1,0,0]
    v_pk_fma_f32 v[10:11], v[104:105], v[122:123], v[10:11] op_sel_hi:[0,1,1] neg_lo:[1,0,0] neg_hi:[1,0,0]
    v_pk_fma_f32 v[24:25], v[104:105], v[124:125], v[24:25] op_sel_hi:[0,1,1] neg_lo:[1,0,0] neg_hi:[1,0,0]
    v_pk_fma_f32 v[26:27], v[104:105], v[126:127], v[26:27] op_sel_hi:[0,1,1] neg_lo:[1,0,0] neg_hi:[1,0,0]
    v_max_f32 v8, 0, v8
    v_max_f32 v9, 0, v9
    v_max_f32 v10, 0, v10
    v_max_f32 v11, 0, v11
    v_pk_mul_f32 v[24:25], v[104:105], v[24:25] op_sel:[1,0] op_sel_hi:[1,1]
    v_pk_mul_f32 v[26:27], v[104:105], v[26:27] op_sel:[1,0] op_sel_hi:[1,1]
    v_pk_mul_f32 v[8:9], v[8:9], v[24:25]
    v_pk_mul_f32 v[10:11], v[10:11], v[26:27]
    v_cvt_pk_bf16_f32 v8, v8, v9
    v_cvt_pk_bf16_f32 v9, v10, v11
    v_pk_fma_f32 v[12:13], v[106:107], v[120:121], v[12:13] op_sel_hi:[0,1,1] neg_lo:[1,0,0] neg_hi:[1,0,0]
    v_pk_fma_f32 v[14:15], v[106:107], v[122:123], v[14:15] op_sel_hi:[0,1,1] neg_lo:[1,0,0] neg_hi:[1,0,0]
    v_pk_fma_f32 v[28:29], v[106:107], v[124:125], v[28:29] op_sel_hi:[0,1,1] neg_lo:[1,0,0] neg_hi:[1,0,0]
    v_pk_fma_f32 v[30:31], v[106:107], v[126:127], v[30:31] op_sel_hi:[0,1,1] neg_lo:[1,0,0] neg_hi:[1,0,0]
    v_max_f32 v12, 0, v12
    v_max_f32 v13, 0, v13
    v_max_f32 v14, 0, v14
    v_max_f32 v15, 0, v15
    v_pk_mul_f32 v[28:29], v[106:107], v[28:29] op_sel:[1,0] op_sel_hi:[1,1]
    v_pk_mul_f32 v[30:31], v[106:107], v[30:31] op_sel:[1,0] op_sel_hi:[1,1]
    v_pk_mul_f32 v[12:13], v[12:13], v[28:29]
    v_pk_mul_f32 v[14:15], v[14:15], v[30:31]
    v_cvt_pk_bf16_f32 v10, v12, v13
    v_cvt_pk_bf16_f32 v11, v14, v15
    s_nop 1
    v_permlane16_swap_b32 v8, v10
    v_permlane16_swap_b32 v9, v11
    buffer_store_dwordx4 v[8:11], v191, s[24:27], s64 offen
    v_pk_fma_f32 v[16:17], v[108:109], v[120:121], v[16:17] op_sel_hi:[0,1,1] neg_lo:[1,0,0] neg_hi:[1,0,0]
    v_pk_fma_f32 v[18:19], v[108:109], v[122:123], v[18:19] op_sel_hi:[0,1,1] neg_lo:[1,0,0] neg_hi:[1,0,0]
    v_pk_fma_f32 v[32:33], v[108:109], v[124:125], v[32:33] op_sel_hi:[0,1,1] neg_lo:[1,0,0] neg_hi:[1,0,0]
    v_pk_fma_f32 v[34:35], v[108:109], v[126:127], v[34:35] op_sel_hi:[0,1,1] neg_lo:[1,0,0] neg_hi:[1,0,0]
    v_max_f32 v16, 0, v16
    v_max_f32 v17, 0, v17
    v_max_f32 v18, 0, v18
    v_max_f32 v19, 0, v19
    v_pk_mul_f32 v[32:33], v[108:109], v[32:33] op_sel:[1,0] op_sel_hi:[1,1]
    v_pk_mul_f32 v[34:35], v[108:109], v[34:35] op_sel:[1,0] op_sel_hi:[1,1]
    v_pk_mul_f32 v[16:17], v[16:17], v[32:33]
    v_pk_mul_f32 v[18:19], v[18:19], v[34:35]
    v_cvt_pk_bf16_f32 v16, v16, v17
    v_cvt_pk_bf16_f32 v17, v18, v19
    v_pk_fma_f32 v[20:21], v[110:111], v[120:121], v[20:21] op_sel_hi:[0,1,1] neg_lo:[1,0,0] neg_hi:[1,0,0]
    v_pk_fma_f32 v[22:23], v[110:111], v[122:123], v[22:23] op_sel_hi:[0,1,1] neg_lo:[1,0,0] neg_hi:[1,0,0]
    v_pk_fma_f32 v[36:37], v[110:111], v[124:125], v[36:37] op_sel_hi:[0,1,1] neg_lo:[1,0,0] neg_hi:[1,0,0]
    v_pk_fma_f32 v[38:39], v[110:111], v[126:127], v[38:39] op_sel_hi:[0,1,1] neg_lo:[1,0,0] neg_hi:[1,0,0]
    v_max_f32 v20, 0, v20
    v_max_f32 v21, 0, v21
    v_max_f32 v22, 0, v22
    v_max_f32 v23, 0, v23
    v_pk_mul_f32 v[36:37], v[110:111], v[36:37] op_sel:[1,0] op_sel_hi:[1,1]
    v_pk_mul_f32 v[38:39], v[110:111], v[38:39] op_sel:[1,0] op_sel_hi:[1,1]
    v_pk_mul_f32 v[20:21], v[20:21], v[36:37]
    v_pk_mul_f32 v[22:23], v[22:23], v[38:39]
    v_cvt_pk_bf16_f32 v18, v20, v21
    v_cvt_pk_bf16_f32 v19, v22, v23
    s_nop 1
    v_permlane16_swap_b32 v16, v18
    v_permlane16_swap_b32 v17, v19
    buffer_store_dwordx4 v[16:19], v191, s[24:27], s66 offen
    v_pk_fma_f32 v[40:41], v[104:105], v[128:129], v[40:41] op_sel_hi:[0,1,1] neg_lo:[1,0,0] neg_hi:[1,0,0]
    v_pk_fma_f32 v[42:43], v[104:105], v[130:131], v[42:43] op_sel_hi:[0,1,1] neg_lo:[1,0,0] neg_hi:[1,0,0]
    v_pk_fma_f32 v[56:57], v[104:105], v[132:133], v[56:57] op_sel_hi:[0,1,1] neg_lo:[1,0,0] neg_hi:[1,0,0]
    v_pk_fma_f32 v[58:59], v[104:105], v[134:135], v[58:59] op_sel_hi:[0,1,1] neg_lo:[1,0,0] neg_hi:[1,0,0]
    v_max_f32 v40, 0, v40
    v_max_f32 v41, 0, v41
    v_max_f32 v42, 0, v42
    v_max_f32 v43, 0, v43
    v_pk_mul_f32 v[56:57], v[104:105], v[56:57] op_sel:[1,0] op_sel_hi:[1,1]
    v_pk_mul_f32 v[58:59], v[104:105], v[58:59] op_sel:[1,0] op_sel_hi:[1,1]
    v_pk_mul_f32 v[40:41], v[40:41], v[56:57]
    v_pk_mul_f32 v[42:43], v[42:43], v[58:59]
    v_cvt_pk_bf16_f32 v40, v40, v41
    v_cvt_pk_bf16_f32 v41, v42, v43
    v_pk_fma_f32 v[72:73], v[104:105], v[136:137], v[72:73] op_sel_hi:[0,1,1] neg_lo:[1,0,0] neg_hi:[1,0,0]
    v_pk_fma_f32 v[74:75], v[104:105], v[138:139], v[74:75] op_sel_hi:[0,1,1] neg_lo:[1,0,0] neg_hi:[1,0,0]
    v_pk_fma_f32 v[88:89], v[104:105], v[140:141], v[88:89] op_sel_hi:[0,1,1] neg_lo:[1,0,0] neg_hi:[1,0,0]
    v_pk_fma_f32 v[90:91], v[104:105], v[142:143], v[90:91] op_sel_hi:[0,1,1] neg_lo:[1,0,0] neg_hi:[1,0,0]
    v_max_f32 v72, 0, v72
    v_max_f32 v73, 0, v73
    v_max_f32 v74, 0, v74
    v_max_f32 v75, 0, v75
    v_pk_mul_f32 v[88:89], v[104:105], v[88:89] op_sel:[1,0] op_sel_hi:[1,1]
    v_pk_mul_f32 v[90:91], v[104:105], v[90:91] op_sel:[1,0] op_sel_hi:[1,1]
    v_pk_mul_f32 v[72:73], v[72:73], v[88:89]
    v_pk_mul_f32 v[74:75], v[74:75], v[90:91]
    v_cvt_pk_bf16_f32 v42, v72, v73
    v_cvt_pk_bf16_f32 v43, v74, v75
    buffer_store_dwordx4 v[40:43], v190, s[24:27], s64 offen
    v_pk_fma_f32 v[44:45], v[106:107], v[128:129], v[44:45] op_sel_hi:[0,1,1] neg_lo:[1,0,0] neg_hi:[1,0,0]
    v_pk_fma_f32 v[46:47], v[106:107], v[130:131], v[46:47] op_sel_hi:[0,1,1] neg_lo:[1,0,0] neg_hi:[1,0,0]
    v_pk_fma_f32 v[60:61], v[106:107], v[132:133], v[60:61] op_sel_hi:[0,1,1] neg_lo:[1,0,0] neg_hi:[1,0,0]
    v_pk_fma_f32 v[62:63], v[106:107], v[134:135], v[62:63] op_sel_hi:[0,1,1] neg_lo:[1,0,0] neg_hi:[1,0,0]
    v_max_f32 v44, 0, v44
    v_max_f32 v45, 0, v45
    v_max_f32 v46, 0, v46
    v_max_f32 v47, 0, v47
    v_pk_mul_f32 v[60:61], v[106:107], v[60:61] op_sel:[1,0] op_sel_hi:[1,1]
    v_pk_mul_f32 v[62:63], v[106:107], v[62:63] op_sel:[1,0] op_sel_hi:[1,1]
    v_pk_mul_f32 v[44:45], v[44:45], v[60:61]
    v_pk_mul_f32 v[46:47], v[46:47], v[62:63]
    v_cvt_pk_bf16_f32 v44, v44, v45
    v_cvt_pk_bf16_f32 v45, v46, v47
    v_pk_fma_f32 v[76:77], v[106:107], v[136:137], v[76:77] op_sel_hi:[0,1,1] neg_lo:[1,0,0] neg_hi:[1,0,0]
    v_pk_fma_f32 v[78:79], v[106:107], v[138:139], v[78:79] op_sel_hi:[0,1,1] neg_lo:[1,0,0] neg_hi:[1,0,0]
    v_pk_fma_f32 v[92:93], v[106:107], v[140:141], v[92:93] op_sel_hi:[0,1,1] neg_lo:[1,0,0] neg_hi:[1,0,0]
    v_pk_fma_f32 v[94:95], v[106:107], v[142:143], v[94:95] op_sel_hi:[0,1,1] neg_lo:[1,0,0] neg_hi:[1,0,0]
    v_max_f32 v76, 0, v76
    v_max_f32 v77, 0, v77
    v_max_f32 v78, 0, v78
    v_max_f32 v79, 0, v79
    v_pk_mul_f32 v[92:93], v[106:107], v[92:93] op_sel:[1,0] op_sel_hi:[1,1]
    v_pk_mul_f32 v[94:95], v[106:107], v[94:95] op_sel:[1,0] op_sel_hi:[1,1]
    v_pk_mul_f32 v[76:77], v[76:77], v[92:93]
    v_pk_mul_f32 v[78:79], v[78:79], v[94:95]
    v_cvt_pk_bf16_f32 v46, v76, v77
    v_cvt_pk_bf16_f32 v47, v78, v79
    buffer_store_dwordx4 v[44:47], v190, s[24:27], s65 offen
    v_pk_fma_f32 v[48:49], v[108:109], v[128:129], v[48:49] op_sel_hi:[0,1,1] neg_lo:[1,0,0] neg_hi:[1,0,0]
    v_pk_fma_f32 v[50:51], v[108:109], v[130:131], v[50:51] op_sel_hi:[0,1,1] neg_lo:[1,0,0] neg_hi:[1,0,0]
    v_pk_fma_f32 v[64:65], v[108:109], v[132:133], v[64:65] op_sel_hi:[0,1,1] neg_lo:[1,0,0] neg_hi:[1,0,0]
    v_pk_fma_f32 v[66:67], v[108:109], v[134:135], v[66:67] op_sel_hi:[0,1,1] neg_lo:[1,0,0] neg_hi:[1,0,0]
    v_max_f32 v48, 0, v48
    v_max_f32 v49, 0, v49
    v_max_f32 v50, 0, v50
    v_max_f32 v51, 0, v51
    v_pk_mul_f32 v[64:65], v[108:109], v[64:65] op_sel:[1,0] op_sel_hi:[1,1]
    v_pk_mul_f32 v[66:67], v[108:109], v[66:67] op_sel:[1,0] op_sel_hi:[1,1]
    v_pk_mul_f32 v[48:49], v[48:49], v[64:65]
    v_pk_mul_f32 v[50:51], v[50:51], v[66:67]
    v_cvt_pk_bf16_f32 v48, v48, v49
    v_cvt_pk_bf16_f32 v49, v50, v51
    v_pk_fma_f32 v[80:81], v[108:109], v[136:137], v[80:81] op_sel_hi:[0,1,1] neg_lo:[1,0,0] neg_hi:[1,0,0]
    v_pk_fma_f32 v[82:83], v[108:109], v[138:139], v[82:83] op_sel_hi:[0,1,1] neg_lo:[1,0,0] neg_hi:[1,0,0]
    v_pk_fma_f32 v[96:97], v[108:109], v[140:141], v[96:97] op_sel_hi:[0,1,1] neg_lo:[1,0,0] neg_hi:[1,0,0]
    v_pk_fma_f32 v[98:99], v[108:109], v[142:143], v[98:99] op_sel_hi:[0,1,1] neg_lo:[1,0,0] neg_hi:[1,0,0]
    v_max_f32 v80, 0, v80
    v_max_f32 v81, 0, v81
    v_max_f32 v82, 0, v82
    v_max_f32 v83, 0, v83
    v_pk_mul_f32 v[96:97], v[108:109], v[96:97] op_sel:[1,0] op_sel_hi:[1,1]
    v_pk_mul_f32 v[98:99], v[108:109], v[98:99] op_sel:[1,0] op_sel_hi:[1,1]
    v_pk_mul_f32 v[80:81], v[80:81], v[96:97]
    v_pk_mul_f32 v[82:83], v[82:83], v[98:99]
    v_cvt_pk_bf16_f32 v50, v80, v81
    v_cvt_pk_bf16_f32 v51, v82, v83
    buffer_store_dwordx4 v[48:51], v190, s[24:27], s66 offen
    v_pk_fma_f32 v[52:53], v[110:111], v[128:129], v[52:53] op_sel_hi:[0,1,1] neg_lo:[1,0,0] neg_hi:[1,0,0]
    v_pk_fma_f32 v[54:55], v[110:111], v[130:131], v[54:55] op_sel_hi:[0,1,1] neg_lo:[1,0,0] neg_hi:[1,0,0]
    v_pk_fma_f32 v[68:69], v[110:111], v[132:133], v[68:69] op_sel_hi:[0,1,1] neg_lo:[1,0,0] neg_hi:[1,0,0]
    v_pk_fma_f32 v[70:71], v[110:111], v[134:135], v[70:71] op_sel_hi:[0,1,1] neg_lo:[1,0,0] neg_hi:[1,0,0]
    v_max_f32 v52, 0, v52
    v_max_f32 v53, 0, v53
    v_max_f32 v54, 0, v54
    v_max_f32 v55, 0, v55
    v_pk_mul_f32 v[68:69], v[110:111], v[68:69] op_sel:[1,0] op_sel_hi:[1,1]
    v_pk_mul_f32 v[70:71], v[110:111], v[70:71] op_sel:[1,0] op_sel_hi:[1,1]
    v_pk_mul_f32 v[52:53], v[52:53], v[68:69]
    v_pk_mul_f32 v[54:55], v[54:55], v[70:71]
    v_cvt_pk_bf16_f32 v52, v52, v53
    v_cvt_pk_bf16_f32 v53, v54, v55
    v_pk_fma_f32 v[84:85], v[110:111], v[136:137], v[84:85] op_sel_hi:[0,1,1] neg_lo:[1,0,0] neg_hi:[1,0,0]
    v_pk_fma_f32 v[86:87], v[110:111], v[138:139], v[86:87] op_sel_hi:[0,1,1] neg_lo:[1,0,0] neg_hi:[1,0,0]
    v_pk_fma_f32 v[100:101], v[110:111], v[140:141], v[100:101] op_sel_hi:[0,1,1] neg_lo:[1,0,0] neg_hi:[1,0,0]
    v_pk_fma_f32 v[102:103], v[110:111], v[142:143], v[102:103] op_sel_hi:[0,1,1] neg_lo:[1,0,0] neg_hi:[1,0,0]
    v_max_f32 v84, 0, v84
    v_max_f32 v85, 0, v85
    v_max_f32 v86, 0, v86
    v_max_f32 v87, 0, v87
    v_pk_mul_f32 v[100:101], v[110:111], v[100:101] op_sel:[1,0] op_sel_hi:[1,1]
    v_pk_mul_f32 v[102:103], v[110:111], v[102:103] op_sel:[1,0] op_sel_hi:[1,1]
    v_pk_mul_f32 v[84:85], v[84:85], v[100:101]
    v_pk_mul_f32 v[86:87], v[86:87], v[102:103]
    v_cvt_pk_bf16_f32 v54, v84, v85
    v_cvt_pk_bf16_f32 v55, v86, v87
    buffer_store_dwordx4 v[52:55], v190, s[24:27], s67 offen
    v_lshlrev_b32 v192, 4, v1
    s_and_b32 s65, s3, 1
    s_lshl_b32 s62, s36, 2
    s_add_u32 s62, s62, s3
    s_mul_i32 s63, s65, 10240
    v_add_u32 v193, s63, v192
    v_add_u32 v194, 61440, v193
    v_add_u32 v195, 122880, v193
    s_lshl_b32 s65, s65, 11
    s_add_u32 s65, s65, s7
    s_add_u32 s65, s65, 16039936
    s_xor_b32 s63, s62, 1
    s_mul_i32 s63, s63, 49152
    s_add_u32 s69, s63, s65
    s_mul_i32 s62, s62, 49152
    s_add_u32 s68, s62, s65
    s_lshl_b32 s46, s38, 4
    s_add_u32 s46, s46, s39
    s_add_u32 s60, s84, s7
    s_add_u32 s60, s60, 22380544
    s_add_u32 s61, s85, s7
    s_add_u32 s61, s61, 27623424
    v_lshlrev_b32 v104, 16, v246
    v_and_b32 v105, 0xffff0000, v246
    v_lshlrev_b32 v106, 16, v247
    v_and_b32 v107, 0xffff0000, v247
    v_lshlrev_b32 v108, 16, v248
    v_and_b32 v109, 0xffff0000, v248
    v_lshlrev_b32 v110, 16, v249
    v_and_b32 v111, 0xffff0000, v249
    v_lshlrev_b32 v112, 16, v250
    v_and_b32 v113, 0xffff0000, v250
    v_lshlrev_b32 v114, 16, v251
    v_and_b32 v115, 0xffff0000, v251
    v_lshlrev_b32 v116, 16, v252
    v_and_b32 v117, 0xffff0000, v252
    v_lshlrev_b32 v118, 16, v253
    v_and_b32 v119, 0xffff0000, v253
    v_lshlrev_b32 v120, 16, v254
    v_and_b32 v121, 0xffff0000, v254
    v_lshlrev_b32 v122, 16, v255
    v_and_b32 v123, 0xffff0000, v255
    s_waitcnt vmcnt(0)
    s_barrier
    s_cmp_lg_u32 s3, 0
    s_cbranch_scc1 Lw0_29
    s_lshl_b32 s44, s46, 2
    s_add_u32 s44, s44, s7
    s_add_u32 s44, s44, 1024
    s_mov_b64 exec, 1
    v_mov_b32 v2, s28
    s_cmp_eq_u32 s29, 1
    s_cbranch_scc0 Lsg_30
    buffer_store_dword v2, off, s[24:27], s44
    s_branch Lsg_31
Lsg_30:
    buffer_wbl2 sc1
    s_waitcnt vmcnt(0)
    buffer_store_dword v2, off, s[24:27], s44 sc0 sc1
Lsg_31:
    s_mov_b64 exec, -1
Lw0_29:
    ds_read_b128 v[144:147], v193 offset:40960
    ds_read_b128 v[148:151], v193 offset:41984
    ds_read_b128 v[152:155], v193 offset:43008
    ds_read_b128 v[156:159], v193 offset:44032
    ds_read_b128 v[160:163], v193 offset:45056
    s_lshr_b32 s46, s36, 1
    s_lshl_b32 s46, s46, 4
    s_cmp_lg_u32 s3, 0
    s_cbranch_scc1 Lw0_32
    s_lshl_b32 s44, s46, 2
    s_add_u32 s44, s44, s7
    s_add_u32 s44, s44, 1024
    v_lshlrev_b32 v188, 2, v1
    s_mov_b32 s45, 0x8000
    s_mov_b64 exec, 0xffff
Lpoll_33:
    buffer_load_dword v184, v188, s[24:27], s44 offen sc1
    s_waitcnt vmcnt(0)
    v_cmp_ne_u32 vcc, s28, v184
    s_sub_u32 s45, s45, 1
    s_cmp_eq_u32 s45, 0
    s_cbranch_scc1 Lpd_34
    s_cmp_lg_u64 vcc, 0
    s_cbranch_scc1 Lpoll_33
Lpd_34:
    s_mov_b64 exec, -1
Lw0_32:
    s_barrier
    buffer_load_dwordx4 v[12:15], v192, s[24:27], s69 offen offset:0 sc1
    buffer_load_dwordx4 v[8:11], v192, s[24:27], s68 offen offset:0 sc1
    buffer_load_dwordx4 v[20:23], v192, s[24:27], s69 offen offset:1024 sc1
    s_add_u32 s69, s69, 4096
    buffer_load_dwordx4 v[16:19], v192, s[24:27], s68 offen offset:1024 sc1
    s_add_u32 s68, s68, 4096
    buffer_load_dwordx4 v[28:31], v192, s[24:27], s69 offen offset:0 sc1
    buffer_load_dwordx4 v[24:27], v192, s[24:27], s68 offen offset:0 sc1
    buffer_load_dwordx4 v[36:39], v192, s[24:27], s69 offen offset:1024 sc1
    s_add_u32 s69, s69, 4096
    buffer_load_dwordx4 v[32:35], v192, s[24:27], s68 offen offset:1024 sc1
    s_add_u32 s68, s68, 4096
    s_cmp_eq_u32 s7, 0
    s_cbranch_scc1 Lfo_35
    s_lshl_b32 s63, s36, 2
    s_add_u32 s63, s63, s3
    s_lshl_b32 s63, s63, 4
    v_and_or_b32 v5, v1, 15, s63
    v_mul_u32_u24 v5, 1280, v5
    v_lshrrev_b32 v4, 4, v1
    v_lshl_add_u32 v240, v4, 3, v5
    s_mul_i32 s60, s37, 160
    v_lshrrev_b32 v6, 1, v4
    v_lshl_add_u32 v5, v6, 4, v5
    v_and_b32 v4, 1, v4
    v_lshl_add_u32 v241, v4, 5, v5
Lfo_35:
dn_loop:
    s_waitcnt vmcnt(6)
    s_waitcnt lgkmcnt(0)
    v_mfma_f32_16x16x32_bf16 v[124:127], v[144:147], v[12:15], 0
    ds_read_b128 v[164:167], v193 offset:46080
    v_mfma_f32_16x16x32_bf16 v[104:107], v[144:147], v[8:11], v[104:107]
    ds_read_b128 v[168:171], v193 offset:47104
    v_mfma_f32_16x16x32_bf16 v[128:131], v[148:151], v[12:15], 0
    ds_read_b128 v[172:175], v193 offset:48128
    v_mfma_f32_16x16x32_bf16 v[108:111], v[148:151], v[8:11], v[108:111]
    ds_read_b128 v[176:179], v193 offset:49152
    v_mfma_f32_16x16x32_bf16 v[132:135], v[152:155], v[12:15], 0
    ds_read_b128 v[180:183], v193 offset:50176
    v_mfma_f32_16x16x32_bf16 v[112:115], v[152:155], v[8:11], v[112:115]
    buffer_load_dwordx4 v[44:47], v192, s[24:27], s69 offen offset:0 sc1
    v_mfma_f32_16x16x32_bf16 v[136:139], v[156:159], v[12:15], 0
    buffer_load_dwordx4 v[40:43], v192, s[24:27], s68 offen offset:0 sc1
    v_mfma_f32_16x16x32_bf16 v[116:119], v[156:159], v[8:11], v[116:119]
    buffer_load_dwordx4 v[52:55], v192, s[24:27], s69 offen offset:1024 sc1
    s_add_u32 s69, s69, 4096
    v_mfma_f32_16x16x32_bf16 v[140:143], v[160:163], v[12:15], 0
    buffer_load_dwordx4 v[48:51], v192, s[24:27], s68 offen offset:1024 sc1
    s_add_u32 s68, s68, 4096
    v_mfma_f32_16x16x32_bf16 v[120:123], v[160:163], v[8:11], v[120:123]
    s_waitcnt vmcnt(8)
    s_waitcnt lgkmcnt(0)
    v_mfma_f32_16x16x32_bf16 v[124:127], v[164:167], v[20:23], v[124:127]
    ds_read_b128 v[144:147], v194 offset:0
    v_mfma_f32_16x16x32_bf16 v[104:107], v[164:167], v[16:19], v[104:107]
    ds_read_b128 v[148:151], v194 offset:1024
    v_mfma_f32_16x16x32_bf16 v[128:131], v[168:171], v[20:23], v[128:131]
    ds_read_b128 v[152:155], v194 offset:2048
    v_mfma_f32_16x16x32_bf16 v[108:111], v[168:171], v[16:19], v[108:111]
    ds_read_b128 v[156:159], v194 offset:3072
    v_mfma_f32_16x16x32_bf16 v[132:135], v[172:175], v[20:23], v[132:135]
    ds_read_b128 v[160:163], v194 offset:4096
    v_mfma_f32_16x16x32_bf16 v[112:115], v[172:175], v[16:19], v[112:115]
    buffer_load_dwordx4 v[60:63], v192, s[24:27], s69 offen offset:0 sc1
    v_mfma_f32_16x16x32_bf16 v[136:139], v[176:179], v[20:23], v[136:139]
    buffer_load_dwordx4 v[56:59], v192, s[24:27], s68 offen offset:0 sc1
    v_mfma_f32_16x16x32_bf16 v[116:119], v[176:179], v[16:19], v[116:119]
    buffer_load_dwordx4 v[68:71], v192, s[24:27], s69 offen offset:1024 sc1
    s_add_u32 s69, s69, 4096
    v_mfma_f32_16x16x32_bf16 v[140:143], v[180:183], v[20:23], v[140:143]
    buffer_load_dwordx4 v[64:67], v192, s[24:27], s68 offen offset:1024 sc1
    s_add_u32 s68, s68, 4096
    v_mfma_f32_16x16x32_bf16 v[120:123], v[180:183], v[16:19], v[120:123]
    s_waitcnt vmcnt(10)
    s_waitcnt lgkmcnt(0)
    v_mfma_f32_16x16x32_bf16 v[124:127], v[144:147], v[28:31], v[124:127]
    ds_read_b128 v[164:167], v194 offset:5120
    v_mfma_f32_16x16x32_bf16 v[104:107], v[144:147], v[24:27], v[104:107]
    ds_read_b128 v[168:171], v194 offset:6144
    v_mfma_f32_16x16x32_bf16 v[128:131], v[148:151], v[28:31], v[128:131]
    ds_read_b128 v[172:175], v194 offset:7168
    v_mfma_f32_16x16x32_bf16 v[108:111], v[148:151], v[24:27], v[108:111]
    ds_read_b128 v[176:179], v194 offset:8192
    v_mfma_f32_16x16x32_bf16 v[132:135], v[152:155], v[28:31], v[132:135]
    ds_read_b128 v[180:183], v194 offset:9216
    v_mfma_f32_16x16x32_bf16 v[112:115], v[152:155], v[24:27], v[112:115]
    buffer_load_dwordx4 v[12:15], v192, s[24:27], s69 offen offset:0 sc1
    v_mfma_f32_16x16x32_bf16 v[136:139], v[156:159], v[28:31], v[136:139]
    buffer_load_dwordx4 v[8:11], v192, s[24:27], s68 offen offset:0 sc1
    v_mfma_f32_16x16x32_bf16 v[116:119], v[156:159], v[24:27], v[116:119]
    buffer_load_dwordx4 v[20:23], v192, s[24:27], s69 offen offset:1024 sc1
    s_add_u32 s69, s69, 4096
    v_mfma_f32_16x16x32_bf16 v[140:143], v[160:163], v[28:31], v[140:143]
    buffer_load_dwordx4 v[16:19], v192, s[24:27], s68 offen offset:1024 sc1
    s_add_u32 s68, s68, 4096
    v_mfma_f32_16x16x32_bf16 v[120:123], v[160:163], v[24:27], v[120:123]
    s_waitcnt vmcnt(12)
    s_waitcnt lgkmcnt(0)
    v_mfma_f32_16x16x32_bf16 v[124:127], v[164:167], v[36:39], v[124:127]
    s_barrier
    ds_read_b128 v[144:147], v194 offset:20480
    v_mfma_f32_16x16x32_bf16 v[104:107], v[164:167], v[32:35], v[104:107]
    ds_read_b128 v[148:151], v194 offset:21504
    v_mfma_f32_16x16x32_bf16 v[128:131], v[168:171], v[36:39], v[128:131]
    ds_read_b128 v[152:155], v194 offset:22528
    v_mfma_f32_16x16x32_bf16 v[108:111], v[168:171], v[32:35], v[108:111]
    ds_read_b128 v[156:159], v194 offset:23552
    v_mfma_f32_16x16x32_bf16 v[132:135], v[172:175], v[36:39], v[132:135]
    ds_read_b128 v[160:163], v194 offset:24576
    v_mfma_f32_16x16x32_bf16 v[112:115], v[172:175], v[32:35], v[112:115]
    buffer_load_dwordx4 v[28:31], v192, s[24:27], s69 offen offset:0 sc1
    v_mfma_f32_16x16x32_bf16 v[136:139], v[176:179], v[36:39], v[136:139]
    buffer_load_dwordx4 v[24:27], v192, s[24:27], s68 offen offset:0 sc1
    v_mfma_f32_16x16x32_bf16 v[116:119], v[176:179], v[32:35], v[116:119]
    v_mfma_f32_16x16x32_bf16 v[140:143], v[180:183], v[36:39], v[140:143]
    v_mfma_f32_16x16x32_bf16 v[120:123], v[180:183], v[32:35], v[120:123]
    s_waitcnt vmcnt(12)
    s_waitcnt lgkmcnt(0)
    v_mfma_f32_16x16x32_bf16 v[124:127], v[144:147], v[44:47], v[124:127]
    ds_read_b128 v[164:167], v194 offset:25600
    v_mfma_f32_16x16x32_bf16 v[104:107], v[144:147], v[40:43], v[104:107]
    ds_read_b128 v[168:171], v194 offset:26624
    v_mfma_f32_16x16x32_bf16 v[128:131], v[148:151], v[44:47], v[128:131]
    ds_read_b128 v[172:175], v194 offset:27648
    v_mfma_f32_16x16x32_bf16 v[108:111], v[148:151], v[40:43], v[108:111]
    ds_read_b128 v[176:179], v194 offset:28672
    v_mfma_f32_16x16x32_bf16 v[132:135], v[152:155], v[44:47], v[132:135]
    ds_read_b128 v[180:183], v194 offset:29696
    v_mfma_f32_16x16x32_bf16 v[112:115], v[152:155], v[40:43], v[112:115]
    buffer_load_dwordx4 v[36:39], v192, s[24:27], s69 offen offset:1024 sc1
    s_add_u32 s69, s69, 4096
    v_mfma_f32_16x16x32_bf16 v[136:139], v[156:159], v[44:47], v[136:139]
    buffer_load_dwordx4 v[32:35], v192, s[24:27], s68 offen offset:1024 sc1
    s_add_u32 s68, s68, 4096
    v_mfma_f32_16x16x32_bf16 v[116:119], v[156:159], v[40:43], v[116:119]
    v_mfma_f32_16x16x32_bf16 v[140:143], v[160:163], v[44:47], v[140:143]
    v_mfma_f32_16x16x32_bf16 v[120:123], v[160:163], v[40:43], v[120:123]
    s_waitcnt vmcnt(12)
    s_waitcnt lgkmcnt(0)
    v_mfma_f32_16x16x32_bf16 v[124:127], v[164:167], v[52:55], v[124:127]
    ds_read_b128 v[144:147], v194 offset:40960
    v_mfma_f32_16x16x32_bf16 v[104:107], v[164:167], v[48:51], v[104:107]
    ds_read_b128 v[148:151], v194 offset:41984
    v_mfma_f32_16x16x32_bf16 v[128:131], v[168:171], v[52:55], v[128:131]
    ds_read_b128 v[152:155], v194 offset:43008
    v_mfma_f32_16x16x32_bf16 v[108:111], v[168:171], v[48:51], v[108:111]
    ds_read_b128 v[156:159], v194 offset:44032
    v_mfma_f32_16x16x32_bf16 v[132:135], v[172:175], v[52:55], v[132:135]
    ds_read_b128 v[160:163], v194 offset:45056
    v_mfma_f32_16x16x32_bf16 v[112:115], v[172:175], v[48:51], v[112:115]
    buffer_load_dwordx4 v[44:47], v192, s[24:27], s69 offen offset:0 sc1
    v_mfma_f32_16x16x32_bf16 v[136:139], v[176:179], v[52:55], v[136:139]
    buffer_load_dwordx4 v[40:43], v192, s[24:27], s68 offen offset:0 sc1
    v_mfma_f32_16x16x32_bf16 v[116:119], v[176:179], v[48:51], v[116:119]
    v_mfma_f32_16x16x32_bf16 v[140:143], v[180:183], v[52:55], v[140:143]
    v_mfma_f32_16x16x32_bf16 v[120:123], v[180:183], v[48:51], v[120:123]
    s_waitcnt vmcnt(12)
    s_waitcnt lgkmcnt(0)
    v_mfma_f32_16x16x32_bf16 v[124:127], v[144:147], v[60:63], v[124:127]
    ds_read_b128 v[164:167], v194 offset:46080
    v_mfma_f32_16x16x32_bf16 v[104:107], v[144:147], v[56:59], v[104:107]
    ds_read_b128 v[168:171], v194 offset:47104
    v_mfma_f32_16x16x32_bf16 v[128:131], v[148:151], v[60:63], v[128:131]
    ds_read_b128 v[172:175], v194 offset:48128
    v_mfma_f32_16x16x32_bf16 v[108:111], v[148:151], v[56:59], v[108:111]
    ds_read_b128 v[176:179], v194 offset:49152
    v_mfma_f32_16x16x32_bf16 v[132:135], v[152:155], v[60:63], v[132:135]
    ds_read_b128 v[180:183], v194 offset:50176
    v_mfma_f32_16x16x32_bf16 v[112:115], v[152:155], v[56:59], v[112:115]
    buffer_load_dwordx4 v[52:55], v192, s[24:27], s69 offen offset:1024 sc1
    s_add_u32 s69, s69, 4096
    v_mfma_f32_16x16x32_bf16 v[136:139], v[156:159], v[60:63], v[136:139]
    buffer_load_dwordx4 v[48:51], v192, s[24:27], s68 offen offset:1024 sc1
    s_add_u32 s68, s68, 4096
    v_mfma_f32_16x16x32_bf16 v[116:119], v[156:159], v[56:59], v[116:119]
    v_mfma_f32_16x16x32_bf16 v[140:143], v[160:163], v[60:63], v[140:143]
    v_mfma_f32_16x16x32_bf16 v[120:123], v[160:163], v[56:59], v[120:123]
    s_waitcnt vmcnt(12)
    s_waitcnt lgkmcnt(0)
    v_mfma_f32_16x16x32_bf16 v[124:127], v[164:167], v[68:71], v[124:127]
    s_barrier
    ds_read_b128 v[144:147], v195 offset:0
    v_mfma_f32_16x16x32_bf16 v[104:107], v[164:167], v[64:67], v[104:107]
    ds_read_b128 v[148:151], v195 offset:1024
    v_mfma_f32_16x16x32_bf16 v[128:131], v[168:171], v[68:71], v[128:131]
    ds_read_b128 v[152:155], v195 offset:2048
    v_mfma_f32_16x16x32_bf16 v[108:111], v[168:171], v[64:67], v[108:111]
    ds_read_b128 v[156:159], v195 offset:3072
    v_mfma_f32_16x16x32_bf16 v[132:135], v[172:175], v[68:71], v[132:135]
    ds_read_b128 v[160:163], v195 offset:4096
    v_mfma_f32_16x16x32_bf16 v[112:115], v[172:175], v[64:67], v[112:115]
    buffer_load_dwordx4 v[60:63], v192, s[24:27], s69 offen offset:0 sc1
    v_mfma_f32_16x16x32_bf16 v[136:139], v[176:179], v[68:71], v[136:139]
    buffer_load_dwordx4 v[56:59], v192, s[24:27], s68 offen offset:0 sc1
    v_mfma_f32_16x16x32_bf16 v[116:119], v[176:179], v[64:67], v[116:119]
    v_mfma_f32_16x16x32_bf16 v[140:143], v[180:183], v[68:71], v[140:143]
    v_mfma_f32_16x16x32_bf16 v[120:123], v[180:183], v[64:67], v[120:123]
    s_waitcnt vmcnt(12)
    s_waitcnt lgkmcnt(0)
    v_mfma_f32_16x16x32_bf16 v[124:127], v[144:147], v[12:15], v[124:127]
    ds_read_b128 v[164:167], v195 offset:5120
    v_mfma_f32_16x16x32_bf16 v[104:107], v[144:147], v[8:11], v[104:107]
    ds_read_b128 v[168:171], v195 offset:6144
    v_mfma_f32_16x16x32_bf16 v[128:131], v[148:151], v[12:15], v[128:131]
    ds_read_b128 v[172:175], v195 offset:7168
    v_mfma_f32_16x16x32_bf16 v[108:111], v[148:151], v[8:11], v[108:111]
    ds_read_b128 v[176:179], v195 offset:8192
    v_mfma_f32_16x16x32_bf16 v[132:135], v[152:155], v[12:15], v[132:135]
    ds_read_b128 v[180:183], v195 offset:9216
    v_mfma_f32_16x16x32_bf16 v[112:115], v[152:155], v[8:11], v[112:115]
    buffer_load_dwordx4 v[68:71], v192, s[24:27], s69 offen offset:1024 sc1
    s_add_u32 s69, s69, 4096
    v_mfma_f32_16x16x32_bf16 v[136:139], v[156:159], v[12:15], v[136:139]
    buffer_load_dwordx4 v[64:67], v192, s[24:27], s68 offen offset:1024 sc1
    s_add_u32 s68, s68, 4096
    v_mfma_f32_16x16x32_bf16 v[116:119], v[156:159], v[8:11], v[116:119]
    v_mfma_f32_16x16x32_bf16 v[140:143], v[160:163], v[12:15], v[140:143]
    v_mfma_f32_16x16x32_bf16 v[120:123], v[160:163], v[8:11], v[120:123]
    s_waitcnt vmcnt(12)
    s_waitcnt lgkmcnt(0)
    v_mfma_f32_16x16x32_bf16 v[124:127], v[164:167], v[20:23], v[124:127]
    ds_read_b128 v[144:147], v195 offset:20480
    v_mfma_f32_16x16x32_bf16 v[104:107], v[164:167], v[16:19], v[104:107]
    ds_read_b128 v[148:151], v195 offset:21504
    v_mfma_f32_16x16x32_bf16 v[128:131], v[168:171], v[20:23], v[128:131]
    ds_read_b128 v[152:155], v195 offset:22528
    v_mfma_f32_16x16x32_bf16 v[108:111], v[168:171], v[16:19], v[108:111]
    ds_read_b128 v[156:159], v195 offset:23552
    v_mfma_f32_16x16x32_bf16 v[132:135], v[172:175], v[20:23], v[132:135]
    ds_read_b128 v[160:163], v195 offset:24576
    v_mfma_f32_16x16x32_bf16 v[112:115], v[172:175], v[16:19], v[112:115]
    buffer_load_dwordx4 v[12:15], v192, s[24:27], s69 offen offset:0 sc1
    v_mfma_f32_16x16x32_bf16 v[136:139], v[176:179], v[20:23], v[136:139]
    buffer_load_dwordx4 v[8:11], v192, s[24:27], s68 offen offset:0 sc1
    v_mfma_f32_16x16x32_bf16 v[116:119], v[176:179], v[16:19], v[116:119]
    v_mfma_f32_16x16x32_bf16 v[140:143], v[180:183], v[20:23], v[140:143]
    v_mfma_f32_16x16x32_bf16 v[120:123], v[180:183], v[16:19], v[120:123]
    s_waitcnt vmcnt(12)
    s_waitcnt lgkmcnt(0)
    v_mfma_f32_16x16x32_bf16 v[124:127], v[144:147], v[28:31], v[124:127]
    ds_read_b128 v[164:167], v195 offset:25600
    v_mfma_f32_16x16x32_bf16 v[104:107], v[144:147], v[24:27], v[104:107]
    ds_read_b128 v[168:171], v195 offset:26624
    v_mfma_f32_16x16x32_bf16 v[128:131], v[148:151], v[28:31], v[128:131]
    ds_read_b128 v[172:175], v195 offset:27648
    v_mfma_f32_16x16x32_bf16 v[108:111], v[148:151], v[24:27], v[108:111]
    ds_read_b128 v[176:179], v195 offset:28672
    v_mfma_f32_16x16x32_bf16 v[132:135], v[152:155], v[28:31], v[132:135]
    ds_read_b128 v[180:183], v195 offset:29696
    v_mfma_f32_16x16x32_bf16 v[112:115], v[152:155], v[24:27], v[112:115]
    buffer_load_dwordx4 v[20:23], v192, s[24:27], s69 offen offset:1024 sc1
    s_add_u32 s69, s69, 4096
    v_mfma_f32_16x16x32_bf16 v[136:139], v[156:159], v[28:31], v[136:139]
    buffer_load_dwordx4 v[16:19], v192, s[24:27], s68 offen offset:1024 sc1
    s_add_u32 s68, s68, 4096
    v_mfma_f32_16x16x32_bf16 v[116:119], v[156:159], v[24:27], v[116:119]
    v_mfma_f32_16x16x32_bf16 v[140:143], v[160:163], v[28:31], v[140:143]
    v_mfma_f32_16x16x32_bf16 v[120:123], v[160:163], v[24:27], v[120:123]
    s_waitcnt vmcnt(12)
    s_waitcnt lgkmcnt(0)
    v_mfma_f32_16x16x32_bf16 v[124:127], v[164:167], v[36:39], v[124:127]
    ds_read_b128 v[144:147], v193 offset:0
    v_mfma_f32_16x16x32_bf16 v[104:107], v[164:167], v[32:35], v[104:107]
    ds_read_b128 v[148:151], v193 offset:1024
    v_mfma_f32_16x16x32_bf16 v[128:131], v[168:171], v[36:39], v[128:131]
    ds_read_b128 v[152:155], v193 offset:2048
    v_mfma_f32_16x16x32_bf16 v[108:111], v[168:171], v[32:35], v[108:111]
    ds_read_b128 v[156:159], v193 offset:3072
    v_mfma_f32_16x16x32_bf16 v[132:135], v[172:175], v[36:39], v[132:135]
    ds_read_b128 v[160:163], v193 offset:4096
    v_mfma_f32_16x16x32_bf16 v[112:115], v[172:175], v[32:35], v[112:115]
    buffer_load_dwordx4 v[28:31], v192, s[24:27], s69 offen offset:0 sc1
    v_mfma_f32_16x16x32_bf16 v[136:139], v[176:179], v[36:39], v[136:139]
    buffer_load_dwordx4 v[24:27], v192, s[24:27], s68 offen offset:0 sc1
    v_mfma_f32_16x16x32_bf16 v[116:119], v[176:179], v[32:35], v[116:119]
    v_mfma_f32_16x16x32_bf16 v[140:143], v[180:183], v[36:39], v[140:143]
    v_mfma_f32_16x16x32_bf16 v[120:123], v[180:183], v[32:35], v[120:123]
    s_waitcnt vmcnt(12)
    s_waitcnt lgkmcnt(0)
    v_mfma_f32_16x16x32_bf16 v[124:127], v[144:147], v[44:47], v[124:127]
    ds_read_b128 v[164:167], v193 offset:5120
    v_mfma_f32_16x16x32_bf16 v[104:107], v[144:147], v[40:43], v[104:107]
    ds_read_b128 v[168:171], v193 offset:6144
    v_mfma_f32_16x16x32_bf16 v[128:131], v[148:151], v[44:47], v[128:131]
    ds_read_b128 v[172:175], v193 offset:7168
    v_mfma_f32_16x16x32_bf16 v[108:111], v[148:151], v[40:43], v[108:111]
    ds_read_b128 v[176:179], v193 offset:8192
    v_mfma_f32_16x16x32_bf16 v[132:135], v[152:155], v[44:47], v[132:135]
    ds_read_b128 v[180:183], v193 offset:9216
    v_mfma_f32_16x16x32_bf16 v[112:115], v[152:155], v[40:43], v[112:115]
    buffer_load_dwordx4 v[36:39], v192, s[24:27], s69 offen offset:1024 sc1
    s_add_u32 s69, s69, 4096
    v_mfma_f32_16x16x32_bf16 v[136:139], v[156:159], v[44:47], v[136:139]
    buffer_load_dwordx4 v[32:35], v192, s[24:27], s68 offen offset:1024 sc1
    s_add_u32 s68, s68, 4096
    v_mfma_f32_16x16x32_bf16 v[116:119], v[156:159], v[40:43], v[116:119]
    v_mfma_f32_16x16x32_bf16 v[140:143], v[160:163], v[44:47], v[140:143]
    v_mfma_f32_16x16x32_bf16 v[120:123], v[160:163], v[40:43], v[120:123]
    s_waitcnt vmcnt(12)
    s_waitcnt lgkmcnt(0)
    v_mfma_f32_16x16x32_bf16 v[124:127], v[164:167], v[52:55], v[124:127]
    ds_read_b128 v[144:147], v193 offset:20480
    v_mfma_f32_16x16x32_bf16 v[104:107], v[164:167], v[48:51], v[104:107]
    ds_read_b128 v[148:151], v193 offset:21504
    v_mfma_f32_16x16x32_bf16 v[128:131], v[168:171], v[52:55], v[128:131]
    ds_read_b128 v[152:155], v193 offset:22528
    v_mfma_f32_16x16x32_bf16 v[108:111], v[168:171], v[48:51], v[108:111]
    ds_read_b128 v[156:159], v193 offset:23552
    v_mfma_f32_16x16x32_bf16 v[132:135], v[172:175], v[52:55], v[132:135]
    ds_read_b128 v[160:163], v193 offset:24576
    v_mfma_f32_16x16x32_bf16 v[112:115], v[172:175], v[48:51], v[112:115]
    buffer_load_dwordx4 v[44:47], v192, s[24:27], s69 offen offset:0 sc1
    v_mfma_f32_16x16x32_bf16 v[136:139], v[176:179], v[52:55], v[136:139]
    buffer_load_dwordx4 v[40:43], v192, s[24:27], s68 offen offset:0 sc1
    v_mfma_f32_16x16x32_bf16 v[116:119], v[176:179], v[48:51], v[116:119]
    v_mfma_f32_16x16x32_bf16 v[140:143], v[180:183], v[52:55], v[140:143]
    v_mfma_f32_16x16x32_bf16 v[120:123], v[180:183], v[48:51], v[120:123]
    s_waitcnt vmcnt(12)
    s_waitcnt lgkmcnt(0)
    v_mfma_f32_16x16x32_bf16 v[124:127], v[144:147], v[60:63], v[124:127]
    ds_read_b128 v[164:167], v193 offset:25600
    v_mfma_f32_16x16x32_bf16 v[104:107], v[144:147], v[56:59], v[104:107]
    ds_read_b128 v[168:171], v193 offset:26624
    v_mfma_f32_16x16x32_bf16 v[128:131], v[148:151], v[60:63], v[128:131]
    ds_read_b128 v[172:175], v193 offset:27648
    v_mfma_f32_16x16x32_bf16 v[108:111], v[148:151], v[56:59], v[108:111]
    ds_read_b128 v[176:179], v193 offset:28672
    v_mfma_f32_16x16x32_bf16 v[132:135], v[152:155], v[60:63], v[132:135]
    ds_read_b128 v[180:183], v193 offset:29696
    v_mfma_f32_16x16x32_bf16 v[112:115], v[152:155], v[56:59], v[112:115]
    buffer_load_dwordx4 v[52:55], v192, s[24:27], s69 offen offset:1024 sc1
    s_add_u32 s69, s69, 4096
    v_mfma_f32_16x16x32_bf16 v[136:139], v[156:159], v[60:63], v[136:139]
    buffer_load_dwordx4 v[48:51], v192, s[24:27], s68 offen offset:1024 sc1
    s_add_u32 s68, s68, 4096
    v_mfma_f32_16x16x32_bf16 v[116:119], v[156:159], v[56:59], v[116:119]
    v_mfma_f32_16x16x32_bf16 v[140:143], v[160:163], v[60:63], v[140:143]
    v_mfma_f32_16x16x32_bf16 v[120:123], v[160:163], v[56:59], v[120:123]
    s_waitcnt vmcnt(12)
    s_waitcnt lgkmcnt(0)
    v_mfma_f32_16x16x32_bf16 v[124:127], v[164:167], v[68:71], v[124:127]
    s_barrier
    ds_read_b128 v[144:147], v193 offset:40960
    v_mfma_f32_16x16x32_bf16 v[104:107], v[164:167], v[64:67], v[104:107]
    ds_read_b128 v[148:151], v193 offset:41984
    v_mfma_f32_16x16x32_bf16 v[128:131], v[168:171], v[68:71], v[128:131]
    ds_read_b128 v[152:155], v193 offset:43008
    v_mfma_f32_16x16x32_bf16 v[108:111], v[168:171], v[64:67], v[108:111]
    ds_read_b128 v[156:159], v193 offset:44032
    v_mfma_f32_16x16x32_bf16 v[132:135], v[172:175], v[68:71], v[132:135]
    ds_read_b128 v[160:163], v193 offset:45056
    v_mfma_f32_16x16x32_bf16 v[112:115], v[172:175], v[64:67], v[112:115]
    buffer_load_dwordx4 v[60:63], v192, s[24:27], s69 offen offset:0 sc1
    v_mfma_f32_16x16x32_bf16 v[136:139], v[176:179], v[68:71], v[136:139]
    buffer_load_dwordx4 v[56:59], v192, s[24:27], s68 offen offset:0 sc1
    v_mfma_f32_16x16x32_bf16 v[116:119], v[176:179], v[64:67], v[116:119]
    v_mfma_f32_16x16x32_bf16 v[140:143], v[180:183], v[68:71], v[140:143]
    v_mfma_f32_16x16x32_bf16 v[120:123], v[180:183], v[64:67], v[120:123]
    s_waitcnt vmcnt(12)
    s_waitcnt lgkmcnt(0)
    v_mfma_f32_16x16x32_bf16 v[124:127], v[144:147], v[12:15], v[124:127]
    ds_read_b128 v[164:167], v193 offset:46080
    v_mfma_f32_16x16x32_bf16 v[104:107], v[144:147], v[8:11], v[104:107]
    ds_read_b128 v[168:171], v193 offset:47104
    v_mfma_f32_16x16x32_bf16 v[128:131], v[148:151], v[12:15], v[128:131]
    ds_read_b128 v[172:175], v193 offset:48128
    v_mfma_f32_16x16x32_bf16 v[108:111], v[148:151], v[8:11], v[108:111]
    ds_read_b128 v[176:179], v193 offset:49152
    v_mfma_f32_16x16x32_bf16 v[132:135], v[152:155], v[12:15], v[132:135]
    ds_read_b128 v[180:183], v193 offset:50176
    v_mfma_f32_16x16x32_bf16 v[112:115], v[152:155], v[8:11], v[112:115]
    buffer_load_dwordx4 v[68:71], v192, s[24:27], s69 offen offset:1024 sc1
    s_add_u32 s69, s69, 4096
    v_mfma_f32_16x16x32_bf16 v[136:139], v[156:159], v[12:15], v[136:139]
    buffer_load_dwordx4 v[64:67], v192, s[24:27], s68 offen offset:1024 sc1
    s_add_u32 s68, s68, 4096
    v_mfma_f32_16x16x32_bf16 v[116:119], v[156:159], v[8:11], v[116:119]
    v_mfma_f32_16x16x32_bf16 v[140:143], v[160:163], v[12:15], v[140:143]
    v_mfma_f32_16x16x32_bf16 v[120:123], v[160:163], v[8:11], v[120:123]
    s_waitcnt vmcnt(12)
    s_waitcnt lgkmcnt(0)
    v_mfma_f32_16x16x32_bf16 v[124:127], v[164:167], v[20:23], v[124:127]
    ds_read_b128 v[144:147], v194 offset:0
    v_mfma_f32_16x16x32_bf16 v[104:107], v[164:167], v[16:19], v[104:107]
    ds_read_b128 v[148:151], v194 offset:1024
    v_mfma_f32_16x16x32_bf16 v[128:131], v[168:171], v[20:23], v[128:131]
    ds_read_b128 v[152:155], v194 offset:2048
    v_mfma_f32_16x16x32_bf16 v[108:111], v[168:171], v[16:19], v[108:111]
    ds_read_b128 v[156:159], v194 offset:3072
    v_mfma_f32_16x16x32_bf16 v[132:135], v[172:175], v[20:23], v[132:135]
    ds_read_b128 v[160:163], v194 offset:4096
    v_mfma_f32_16x16x32_bf16 v[112:115], v[172:175], v[16:19], v[112:115]
    v_mfma_f32_16x16x32_bf16 v[136:139], v[176:179], v[20:23], v[136:139]
    v_mfma_f32_16x16x32_bf16 v[116:119], v[176:179], v[16:19], v[116:119]
    v_mfma_f32_16x16x32_bf16 v[140:143], v[180:183], v[20:23], v[140:143]
    v_mfma_f32_16x16x32_bf16 v[120:123], v[180:183], v[16:19], v[120:123]
    s_waitcnt vmcnt(10)
    s_waitcnt lgkmcnt(0)
    v_mfma_f32_16x16x32_bf16 v[124:127], v[144:147], v[28:31], v[124:127]
    ds_read_b128 v[164:167], v194 offset:5120
    v_mfma_f32_16x16x32_bf16 v[104:107], v[144:147], v[24:27], v[104:107]
    ds_read_b128 v[168:171], v194 offset:6144
    v_mfma_f32_16x16x32_bf16 v[128:131], v[148:151], v[28:31], v[128:131]
    ds_read_b128 v[172:175], v194 offset:7168
    v_mfma_f32_16x16x32_bf16 v[108:111], v[148:151], v[24:27], v[108:111]
    ds_read_b128 v[176:179], v194 offset:8192
    v_mfma_f32_16x16x32_bf16 v[132:135], v[152:155], v[28:31], v[132:135]
    ds_read_b128 v[180:183], v194 offset:9216
    v_mfma_f32_16x16x32_bf16 v[112:115], v[152:155], v[24:27], v[112:115]
    v_mfma_f32_16x16x32_bf16 v[136:139], v[156:159], v[28:31], v[136:139]
    v_mfma_f32_16x16x32_bf16 v[116:119], v[156:159], v[24:27], v[116:119]
    v_mfma_f32_16x16x32_bf16 v[140:143], v[160:163], v[28:31], v[140:143]
    v_mfma_f32_16x16x32_bf16 v[120:123], v[160:163], v[24:27], v[120:123]
    s_waitcnt vmcnt(8)
    s_waitcnt lgkmcnt(0)
    v_mfma_f32_16x16x32_bf16 v[124:127], v[164:167], v[36:39], v[124:127]
    ds_read_b128 v[144:147], v194 offset:20480
    v_mfma_f32_16x16x32_bf16 v[104:107], v[164:167], v[32:35], v[104:107]
    ds_read_b128 v[148:151], v194 offset:21504
    v_mfma_f32_16x16x32_bf16 v[128:131], v[168:171], v[36:39], v[128:131]
    ds_read_b128 v[152:155], v194 offset:22528
    v_mfma_f32_16x16x32_bf16 v[108:111], v[168:171], v[32:35], v[108:111]
    ds_read_b128 v[156:159], v194 offset:23552
    v_mfma_f32_16x16x32_bf16 v[132:135], v[172:175], v[36:39], v[132:135]
    ds_read_b128 v[160:163], v194 offset:24576
    v_mfma_f32_16x16x32_bf16 v[112:115], v[172:175], v[32:35], v[112:115]
    v_mfma_f32_16x16x32_bf16 v[136:139], v[176:179], v[36:39], v[136:139]
    v_mfma_f32_16x16x32_bf16 v[116:119], v[176:179], v[32:35], v[116:119]
    v_mfma_f32_16x16x32_bf16 v[140:143], v[180:183], v[36:39], v[140:143]
    v_mfma_f32_16x16x32_bf16 v[120:123], v[180:183], v[32:35], v[120:123]
    s_waitcnt vmcnt(6)
    s_waitcnt lgkmcnt(0)
    v_mfma_f32_16x16x32_bf16 v[124:127], v[144:147], v[44:47], v[124:127]
    ds_read_b128 v[164:167], v194 offset:25600
    v_mfma_f32_16x16x32_bf16 v[104:107], v[144:147], v[40:43], v[104:107]
    ds_read_b128 v[168:171], v194 offset:26624
    v_mfma_f32_16x16x32_bf16 v[128:131], v[148:151], v[44:47], v[128:131]
    ds_read_b128 v[172:175], v194 offset:27648
    v_mfma_f32_16x16x32_bf16 v[108:111], v[148:151], v[40:43], v[108:111]
    ds_read_b128 v[176:179], v194 offset:28672
    v_mfma_f32_16x16x32_bf16 v[132:135], v[152:155], v[44:47], v[132:135]
    ds_read_b128 v[180:183], v194 offset:29696
    v_mfma_f32_16x16x32_bf16 v[112:115], v[152:155], v[40:43], v[112:115]
    v_mfma_f32_16x16x32_bf16 v[136:139], v[156:159], v[44:47], v[136:139]
    v_mfma_f32_16x16x32_bf16 v[116:119], v[156:159], v[40:43], v[116:119]
    v_mfma_f32_16x16x32_bf16 v[140:143], v[160:163], v[44:47], v[140:143]
    v_mfma_f32_16x16x32_bf16 v[120:123], v[160:163], v[40:43], v[120:123]
    s_waitcnt vmcnt(4)
    s_waitcnt lgkmcnt(0)
    v_mfma_f32_16x16x32_bf16 v[124:127], v[164:167], v[52:55], v[124:127]
    ds_read_b128 v[144:147], v194 offset:40960
    v_mfma_f32_16x16x32_bf16 v[104:107], v[164:167], v[48:51], v[104:107]
    ds_read_b128 v[148:151], v194 offset:41984
    v_mfma_f32_16x16x32_bf16 v[128:131], v[168:171], v[52:55], v[128:131]
    ds_read_b128 v[152:155], v194 offset:43008
    v_mfma_f32_16x16x32_bf16 v[108:111], v[168:171], v[48:51], v[108:111]
    ds_read_b128 v[156:159], v194 offset:44032
    v_mfma_f32_16x16x32_bf16 v[132:135], v[172:175], v[52:55], v[132:135]
    ds_read_b128 v[160:163], v194 offset:45056
    v_mfma_f32_16x16x32_bf16 v[112:115], v[172:175], v[48:51], v[112:115]
    v_mfma_f32_16x16x32_bf16 v[136:139], v[176:179], v[52:55], v[136:139]
    v_mfma_f32_16x16x32_bf16 v[116:119], v[176:179], v[48:51], v[116:119]
    v_mfma_f32_16x16x32_bf16 v[140:143], v[180:183], v[52:55], v[140:143]
    v_mfma_f32_16x16x32_bf16 v[120:123], v[180:183], v[48:51], v[120:123]
    s_waitcnt vmcnt(2)
    s_waitcnt lgkmcnt(0)
    v_mfma_f32_16x16x32_bf16 v[124:127], v[144:147], v[60:63], v[124:127]
    ds_read_b128 v[164:167], v194 offset:46080
    v_mfma_f32_16x16x32_bf16 v[104:107], v[144:147], v[56:59], v[104:107]
    ds_read_b128 v[168:171], v194 offset:47104
    v_mfma_f32_16x16x32_bf16 v[128:131], v[148:151], v[60:63], v[128:131]
    ds_read_b128 v[172:175], v194 offset:48128
    v_mfma_f32_16x16x32_bf16 v[108:111], v[148:151], v[56:59], v[108:111]
    ds_read_b128 v[176:179], v194 offset:49152
    v_mfma_f32_16x16x32_bf16 v[132:135], v[152:155], v[60:63], v[132:135]
    ds_read_b128 v[180:183], v194 offset:50176
    v_mfma_f32_16x16x32_bf16 v[112:115], v[152:155], v[56:59], v[112:115]
    v_mfma_f32_16x16x32_bf16 v[136:139], v[156:159], v[60:63], v[136:139]
    v_mfma_f32_16x16x32_bf16 v[116:119], v[156:159], v[56:59], v[116:119]
    v_mfma_f32_16x16x32_bf16 v[140:143], v[160:163], v[60:63], v[140:143]
    v_mfma_f32_16x16x32_bf16 v[120:123], v[160:163], v[56:59], v[120:123]
    s_waitcnt vmcnt(0)
    s_waitcnt lgkmcnt(0)
    v_mfma_f32_16x16x32_bf16 v[124:127], v[164:167], v[68:71], v[124:127]
    v_mfma_f32_16x16x32_bf16 v[128:131], v[168:171], v[68:71], v[128:131]
    v_mfma_f32_16x16x32_bf16 v[132:135], v[172:175], v[68:71], v[132:135]
    v_mfma_f32_16x16x32_bf16 v[136:139], v[176:179], v[68:71], v[136:139]
    v_mfma_f32_16x16x32_bf16 v[140:143], v[180:183], v[68:71], v[140:143]
    v_mfma_f32_16x16x32_bf16 v[104:107], v[164:167], v[64:67], v[104:107]
    v_mfma_f32_16x16x32_bf16 v[108:111], v[168:171], v[64:67], v[108:111]
    v_mfma_f32_16x16x32_bf16 v[112:115], v[172:175], v[64:67], v[112:115]
    v_mfma_f32_16x16x32_bf16 v[116:119], v[176:179], v[64:67], v[116:119]
    v_mfma_f32_16x16x32_bf16 v[120:123], v[180:183], v[64:67], v[120:123]
    s_nop 2
    ds_write_b128 v242, v[124:127] offset:0
    ds_write_b128 v242, v[128:131] offset:1024
    ds_write_b128 v242, v[132:135] offset:2048
    ds_write_b128 v242, v[136:139] offset:3072
    ds_write_b128 v242, v[140:143] offset:4096
    s_waitcnt lgkmcnt(0)
    s_barrier
    ds_read_b128 v[124:127], v243 offset:0
    ds_read_b128 v[128:131], v243 offset:1024
    ds_read_b128 v[132:135], v243 offset:2048
    ds_read_b128 v[136:139], v243 offset:3072
    ds_read_b128 v[140:143], v243 offset:4096
    s_cmp_eq_u32 s7, 0
    s_cbranch_scc1 Lfe_36
    s_waitcnt lgkmcnt(4)
    v_pk_add_f32 v[104:105], v[104:105], v[124:125]
    v_pk_add_f32 v[106:107], v[106:107], v[126:127]
    v_cvt_pk_bf16_f32 v246, v104, v105
    v_cvt_pk_bf16_f32 v247, v106, v107
    s_waitcnt lgkmcnt(3)
    v_pk_add_f32 v[108:109], v[108:109], v[128:129]
    v_pk_add_f32 v[110:111], v[110:111], v[130:131]
    v_cvt_pk_bf16_f32 v248, v108, v109
    v_cvt_pk_bf16_f32 v249, v110, v111
    s_nop 1
    v_permlane16_swap_b32 v246, v248
    v_permlane16_swap_b32 v247, v249
    buffer_store_dwordx4 v[246:249], v241, s[16:19], s60 offen offset:0
    s_waitcnt lgkmcnt(2)
    v_pk_add_f32 v[112:113], v[112:113], v[132:133]
    v_pk_add_f32 v[114:115], v[114:115], v[134:135]
    v_cvt_pk_bf16_f32 v250, v112, v113
    v_cvt_pk_bf16_f32 v251, v114, v115
    s_waitcnt lgkmcnt(1)
    v_pk_add_f32 v[116:117], v[116:117], v[136:137]
    v_pk_add_f32 v[118:119], v[118:119], v[138:139]
    v_cvt_pk_bf16_f32 v252, v116, v117
    v_cvt_pk_bf16_f32 v253, v118, v119
    s_nop 1
    v_permlane16_swap_b32 v250, v252
    v_permlane16_swap_b32 v251, v253
    buffer_store_dwordx4 v[250:253], v241, s[16:19], s60 offen offset:64
    s_waitcnt lgkmcnt(0)
    v_pk_add_f32 v[120:121], v[120:121], v[140:141]
    v_pk_add_f32 v[122:123], v[122:123], v[142:143]
    v_cvt_pk_bf16_f32 v254, v120, v121
    v_cvt_pk_bf16_f32 v255, v122, v123
    buffer_store_dwordx2 v[254:255], v240, s[16:19], s60 offen offset:128
    s_branch L_fin
Lfe_36:
    s_waitcnt lgkmcnt(4)
    v_pk_add_f32 v[104:105], v[104:105], v[124:125]
    v_pk_add_f32 v[106:107], v[106:107], v[126:127]
    v_cvt_pk_bf16_f32 v246, v104, v105
    v_cvt_pk_bf16_f32 v247, v106, v107
    buffer_store_dwordx2 v[246:247], v240, s[24:27], s60 offen offset:0
    s_waitcnt lgkmcnt(3)
    v_pk_add_f32 v[108:109], v[108:109], v[128:129]
    v_pk_add_f32 v[110:111], v[110:111], v[130:131]
    v_cvt_pk_bf16_f32 v248, v108, v109
    v_cvt_pk_bf16_f32 v249, v110, v111
    buffer_store_dwordx2 v[248:249], v240, s[24:27], s60 offen offset:512
    s_waitcnt lgkmcnt(2)
    v_pk_add_f32 v[112:113], v[112:113], v[132:133]
    v_pk_add_f32 v[114:115], v[114:115], v[134:135]
    v_cvt_pk_bf16_f32 v250, v112, v113
    v_cvt_pk_bf16_f32 v251, v114, v115
    buffer_store_dwordx2 v[250:251], v240, s[24:27], s60 offen offset:1024
    s_waitcnt lgkmcnt(1)
    v_pk_add_f32 v[116:117], v[116:117], v[136:137]
    v_pk_add_f32 v[118:119], v[118:119], v[138:139]
    v_cvt_pk_bf16_f32 v252, v116, v117
    v_cvt_pk_bf16_f32 v253, v118, v119
    buffer_store_dwordx2 v[252:253], v240, s[24:27], s60 offen offset:1536
    s_waitcnt lgkmcnt(0)
    v_pk_add_f32 v[120:121], v[120:121], v[140:141]
    v_pk_add_f32 v[122:123], v[122:123], v[142:143]
    v_cvt_pk_bf16_f32 v254, v120, v121
    v_cvt_pk_bf16_f32 v255, v122, v123
    buffer_store_dwordx2 v[254:255], v240, s[24:27], s60 offen offset:2048
    v_pk_add_f32 v[184:185], v[104:105], v[106:107]
    v_pk_mul_f32 v[186:187], v[104:105], v[104:105]
    v_pk_fma_f32 v[186:187], v[106:107], v[106:107], v[186:187]
    v_pk_add_f32 v[184:185], v[184:185], v[108:109]
    v_pk_fma_f32 v[186:187], v[108:109], v[108:109], v[186:187]
    v_pk_add_f32 v[184:185], v[184:185], v[110:111]
    v_pk_fma_f32 v[186:187], v[110:111], v[110:111], v[186:187]
    v_pk_add_f32 v[184:185], v[184:185], v[112:113]
    v_pk_fma_f32 v[186:187], v[112:113], v[112:113], v[186:187]
    v_pk_add_f32 v[184:185], v[184:185], v[114:115]
    v_pk_fma_f32 v[186:187], v[114:115], v[114:115], v[186:187]
    v_pk_add_f32 v[184:185], v[184:185], v[116:117]
    v_pk_fma_f32 v[186:187], v[116:117], v[116:117], v[186:187]
    v_pk_add_f32 v[184:185], v[184:185], v[118:119]
    v_pk_fma_f32 v[186:187], v[118:119], v[118:119], v[186:187]
    v_pk_add_f32 v[184:185], v[184:185], v[120:121]
    v_pk_fma_f32 v[186:187], v[120:121], v[120:121], v[186:187]
    v_pk_add_f32 v[184:185], v[184:185], v[122:123]
    v_pk_fma_f32 v[186:187], v[122:123], v[122:123], v[186:187]
    v_add_f32 v184, v184, v185
    v_add_f32 v186, v186, v187
    s_nop 1
    v_permlane32_swap_b32 v184, v186
    s_nop 0
    v_add_f32 v184, v184, v186
    v_mov_b32 v186, v184
    s_nop 1
    v_permlane16_swap_b32 v184, v186
    s_nop 0
    v_add_f32 v184, v184, v186
    buffer_store_dword v184, v241, s[24:27], s61 offen
    s_waitcnt vmcnt(0)
    s_barrier
    s_lshl_b32 s46, s36, 3
    s_add_u32 s46, s46, s37
    s_cmp_lg_u32 s3, 0
    s_cbranch_scc1 Lw0_37
    s_lshl_b32 s44, s46, 2
    s_add_u32 s44, s44, s7
    s_add_u32 s44, s44, 2048
    s_mov_b64 exec, 1
    v_mov_b32 v2, s28
    s_cmp_eq_u32 s29, 1
    s_cbranch_scc0 Lsg_38
    buffer_store_dword v2, off, s[24:27], s44
    s_branch Lsg_39
Lsg_38:
    buffer_wbl2 sc1
    s_waitcnt vmcnt(0)
    buffer_store_dword v2, off, s[24:27], s44 sc0 sc1
Lsg_39:
    s_mov_b64 exec, -1
Lw0_37:
    s_mov_b32 s7, 22331392
    s_mov_b32 s34, s38
    s_mov_b32 s35, s39
    s_branch L_qkv_c
L_wo_l:
    s_mul_i32 s44, s6, 6144
    s_add_u32 s44, s44, 65536
    v_add_u32 v13, s44, v3
    v_add_u32 v14, 49152, v13
    s_mov_b32 s53, 114688
    ds_write_b128 v14, v[16:19] offset:0
    ds_write_b128 v14, v[20:23] offset:1024
    ds_write_b128 v14, v[24:27] offset:2048
    ds_write_b128 v14, v[28:31] offset:3072
    ds_write_b128 v14, v[32:35] offset:4096
    ds_write_b128 v14, v[36:39] offset:5120
    ds_write_b128 v14, v[40:43] offset:24576
    ds_write_b128 v14, v[44:47] offset:25600
    ds_write_b128 v14, v[48:51] offset:26624
    ds_write_b128 v14, v[52:55] offset:27648
    ds_write_b128 v14, v[56:59] offset:28672
    ds_write_b128 v14, v[60:63] offset:29696
    v_add_u32 v4, 18432, v3
    s_lshl_b32 s50, s38, 2
    s_add_u32 s50, s50, s6
    s_mul_i32 s50, s50, 40960
    s_add_u32 s50, s50, s7
    s_add_u32 s50, s50, 2670592
    s_mov_b32 s52, 0
    s_mul_i32 s56, s37, 48
    s_add_u32 s56, s56, s6
    s_mul_i32 s56, s56, 5120
    s_add_u32 s56, s56, 49414144
    s_mov_b32 s57, 40960
    v_min_u32 v12, 47, v1
    s_mul_i32 s44, s6, 192
    v_lshl_add_u32 v12, v12, 2, s44
    s_waitcnt lgkmcnt(0)
    s_cmp_lg_u32 s7, 0
    s_cbranch_scc1 Lt_40
    s_call_b64 s[32:33], S_t67
Lt_40:
    s_barrier
    s_waitcnt lgkmcnt(0)
    s_barrier
    s_cmp_lg_u32 s7, 0
    s_cbranch_scc1 Lt_41
    s_call_b64 s[32:33], S_t45
Lt_41:
    s_cmp_eq_u32 s7, 0
    s_cbranch_scc1 Lt_42
    s_call_b64 s[32:33], S_t67
Lt_42:
    s_barrier
    ds_write_b128 v13, v[64:67] offset:0
    ds_write_b128 v13, v[68:71] offset:1024
    ds_write_b128 v13, v[72:75] offset:2048
    ds_write_b128 v13, v[76:79] offset:3072
    ds_write_b128 v13, v[80:83] offset:4096
    ds_write_b128 v13, v[84:87] offset:5120
    ds_write_b128 v13, v[88:91] offset:24576
    ds_write_b128 v13, v[92:95] offset:25600
    ds_write_b128 v13, v[96:99] offset:26624
    ds_write_b128 v13, v[100:103] offset:27648
    ds_write_b128 v13, v[104:107] offset:28672
    ds_write_b128 v13, v[108:111] offset:29696
    s_barrier
    s_barrier
    s_setprio 0
    s_lshl_b32 s44, s6, 12
    s_add_u32 m0, s52, s44
    s_add_u32 s52, s52, 16384
    s_cmp_eq_u32 s52, 65536
    s_cselect_b32 s52, 0, s52
    buffer_load_dwordx4 v3, s[24:27], s50 offen offset:0 sc1 lds
    buffer_load_dwordx4 v3, s[24:27], s50 offen offset:1024 sc1 lds
    buffer_load_dwordx4 v4, s[24:27], s50 offen offset:2048 sc1 lds
    buffer_load_dwordx4 v4, s[24:27], s50 offen offset:3072 sc1 lds
    s_add_u32 s50, s50, 2048
    s_lshl_b32 s44, s6, 12
    s_add_u32 m0, s52, s44
    s_add_u32 s52, s52, 16384
    s_cmp_eq_u32 s52, 65536
    s_cselect_b32 s52, 0, s52
    buffer_load_dwordx4 v3, s[24:27], s50 offen offset:0 sc1 lds
    buffer_load_dwordx4 v3, s[24:27], s50 offen offset:1024 sc1 lds
    buffer_load_dwordx4 v4, s[24:27], s50 offen offset:2048 sc1 lds
    buffer_load_dwordx4 v4, s[24:27], s50 offen offset:3072 sc1 lds
    s_add_u32 s50, s50, 2048
    s_branch L_gu_l1
S_gx:
    s_lshl_b32 s44, s6, 12
    s_add_u32 m0, s52, s44
    s_add_u32 s52, s52, 16384
    s_cmp_eq_u32 s52, 65536
    s_cselect_b32 s52, 0, s52
    buffer_load_dwordx4 v3, s[24:27], s50 offen offset:0 sc1 lds
    buffer_load_dwordx4 v3, s[24:27], s50 offen offset:1024 sc1 lds
    buffer_load_dwordx4 v4, s[24:27], s50 offen offset:2048 sc1 lds
    buffer_load_dwordx4 v4, s[24:27], s50 offen offset:3072 sc1 lds
    s_add_u32 s50, s50, 2048
    s_setpc_b64 s[32:33]
S_gw:
    s_mul_i32 s44, s6, 6144
    s_add_u32 m0, s53, s44
    s_add_u32 s53, s53, 24576
    s_cmp_eq_u32 s53, 163840
    s_cselect_b32 s53, 65536, s53
    buffer_load_dwordx4 v3, s[24:27], s51 offen offset:0 sc1 lds
    buffer_load_dwordx4 v3, s[24:27], s51 offen offset:1024 sc1 lds
    buffer_load_dwordx4 v3, s[24:27], s51 offen offset:2048 sc1 lds
    buffer_load_dwordx4 v3, s[24:27], s51 offen offset:3072 sc1 lds
    s_add_u32 m0, m0, 4096
    s_add_u32 s51, s51, 4096
    buffer_load_dwordx4 v3, s[24:27], s51 offen offset:0 sc1 lds
    buffer_load_dwordx4 v3, s[24:27], s51 offen offset:1024 sc1 lds
    s_add_u32 s51, s51, 20480
    s_setpc_b64 s[32:33]
S_dw:
    s_mul_i32 s44, s6, 5120
    s_add_u32 m0, s57, s44
    s_add_u32 s57, s57, 20480
    s_cmp_eq_u32 s57, 163840
    s_cselect_b32 s57, 0, s57
    buffer_load_dwordx4 v3, s[24:27], s56 offen offset:0 sc1 lds
    buffer_load_dwordx4 v3, s[24:27], s56 offen offset:1024 sc1 lds
    buffer_load_dwordx4 v3, s[24:27], s56 offen offset:2048 sc1 lds
    buffer_load_dwordx4 v3, s[24:27], s56 offen offset:3072 sc1 lds
    s_add_u32 m0, m0, 4096
    s_add_u32 s56, s56, 4096
    buffer_load_dwordx4 v3, s[24:27], s56 offen sc1 lds
    s_add_u32 s56, s56, 16384
    s_setpc_b64 s[32:33]
L_gu_l1:
    s_waitcnt vmcnt(4)
    s_barrier
    s_mul_i32 s44, s6, 5120
    v_add_u32 v240, s44, v3
    v_add_u32 v241, 61440, v240
    v_add_u32 v242, 122880, v240
    s_call_b64 s[32:33], S_gx
    s_call_b64 s[32:33], S_gx
    s_waitcnt vmcnt(8)
    s_waitcnt lgkmcnt(0)
    s_barrier
    s_call_b64 s[32:33], S_gw
    v_and_b32 v5, 31, v1
    v_lshlrev_b32 v5, 3, v5
    v_lshrrev_b32 v6, 5, v1
    v_lshl_add_u32 v6, v6, 16, v5
    s_lshl_b32 s44, s38, 10
    s_lshl_b32 s45, s6, 8
    s_add_u32 s44, s44, s45
    s_add_u32 s44, s44, s7
    s_add_u32 s44, s44, 5423104
    buffer_load_dwordx2 v[56:57], v6, s[24:27], s44 offen sc1
    s_add_u32 s44, s44, 16384
    buffer_load_dwordx2 v[58:59], v6, s[24:27], s44 offen sc1
    s_add_u32 s44, s44, 16384
    buffer_load_dwordx2 v[60:61], v6, s[24:27], s44 offen sc1
    s_add_u32 s44, s44, 16384
    buffer_load_dwordx2 v[62:63], v6, s[24:27], s44 offen sc1
    s_add_u32 s45, s45, 65536
    v_add_u32 v5, s45, v5
    v_lshrrev_b32 v5, 1, v5
    s_waitcnt vmcnt(14)
    s_barrier
    s_call_b64 s[32:33], S_gx
    s_call_b64 s[32:33], S_gw
    s_waitcnt vmcnt(20)
    s_barrier
    s_call_b64 s[32:33], S_gx
    s_call_b64 s[32:33], S_gw
    s_waitcnt vmcnt(16)
    s_barrier
    s_call_b64 s[32:33], S_gx
    s_call_b64 s[32:33], S_gw
    s_waitcnt vmcnt(16)
    s_barrier
    s_call_b64 s[32:33], S_gx
    s_call_b64 s[32:33], S_gw
    s_waitcnt vmcnt(16)
    s_barrier
    s_call_b64 s[32:33], S_gx
    s_call_b64 s[32:33], S_gw
    s_waitcnt vmcnt(16)
    s_barrier
    s_call_b64 s[32:33], S_gx
    s_lshl_b32 s44, s4, 7
    s_add_u32 s44, s44, s7
    s_add_u32 s44, s44, 1024
    s_cmp_eq_u32 s29, 1
    s_cselect_b32 s44, s44, 51888128
    buffer_load_dword v7, off, s[24:27], s44 sc1
    buffer_load_dword v7, off, s[24:27], s44 offset:1024 sc1
    s_waitcnt vmcnt(12)
    v_add_f32 v56, v56, v58
    v_add_f32 v57, v57, v59
    v_add_f32 v60, v60, v62
    v_add_f32 v61, v61, v63
    v_add_f32 v56, v56, v60
    v_add_f32 v57, v57, v61
    v_mov_b32 v58, v56
    v_mov_b32 v59, v57
    s_nop 1
    v_permlane32_swap_b32 v56, v58
    v_permlane32_swap_b32 v57, v59
    s_nop 0
    v_add_f32 v56, v56, v58
    v_add_f32 v57, v57, v59
    v_mul_f32 v56, 0x3acccccd, v56
    v_mul_f32 v57, 0x3acccccd, v57
    v_fma_f32 v57, -v56, v56, v57
    v_max_f32 v57, 0, v57
    v_add_f32 v57, 0x3727c5ac, v57
    v_rsq_f32 v57, v57
    s_nop 0
    ds_write2_b32 v5, v56, v57 offset1:128
    ds_write_b32 v12, v248 offset:33792
    s_waitcnt lgkmcnt(0)
    s_barrier
    s_call_b64 s[32:33], S_dw
    s_call_b64 s[32:33], S_dw
    s_waitcnt vmcnt(12)
    s_barrier
    s_call_b64 s[32:33], S_dw
    s_call_b64 s[32:33], S_dw
    s_barrier
    s_waitcnt vmcnt(0)
    s_mov_b32 s34, s38
    s_mov_b32 s35, s39
    v_bfe_u32 v8, v1, 2, 2
    v_mul_u32_u24 v8, 3840, v8
    v_lshrrev_b32 v2, 4, v1
    v_lshl_add_u32 v8, v2, 6, v8
    v_and_b32 v2, 3, v1
    v_lshl_add_u32 v8, v2, 4, v8
    v_xor_b32 v2, 32, v8
    v_add_u32 v9, 14336, v8
    v_add_u32 v10, 28672, v2
    v_add_u32 v11, 43008, v2
    s_mul_i32 s51, s6, 61440
    s_lshl_b32 s44, s35, 8
    s_add_u32 s51, s51, s44
    s_mov_b32 s53, 131072
    s_mov_b32 s56, 1
    s_cmp_eq_u32 s35, 15
    s_cselect_b32 s51, 2457600, s51
    s_cmp_lg_u32 s7, 0
    s_cselect_b32 s51, 2457600, s51
    s_add_u32 s47, s51, 491520
    v_min_u32 v5, 19, v1
    v_lshlrev_b32 v5, 7, v5
    s_lshl_b32 s44, s36, 2
    s_add_u32 s44, s44, s6
    s_mul_i32 s44, s44, 20480
    s_mul_i32 s45, s37, 2560
    s_add_u32 s44, s44, s45
    s_add_u32 s49, s44, 22380544
    s_cmp_lg_u32 s7, 0
    s_cselect_b32 s49, 51888128, s49
    s_barrier
    s_setprio 0
    ds_write_b128 v242, v[160:163] offset:0
    ds_write_b128 v242, v[164:167] offset:1024
    ds_write_b128 v242, v[168:171] offset:2048
    ds_write_b128 v242, v[172:175] offset:3072
    ds_write_b128 v242, v[176:179] offset:4096
    s_barrier
    s_waitcnt vmcnt(0)
    ds_write_b128 v242, v[180:183] offset:20480
    ds_write_b128 v242, v[184:187] offset:21504
    ds_write_b128 v242, v[188:191] offset:22528
    ds_write_b128 v242, v[192:195] offset:23552
    ds_write_b128 v242, v[196:199] offset:24576
    ds_write_b128 v240, v[200:203] offset:0
    ds_write_b128 v240, v[204:207] offset:1024
    ds_write_b128 v240, v[208:211] offset:2048
    ds_write_b128 v240, v[212:215] offset:3072
    ds_write_b128 v240, v[216:219] offset:4096
    ds_write_b128 v240, v[220:223] offset:20480
    ds_write_b128 v240, v[224:227] offset:21504
    ds_write_b128 v240, v[228:231] offset:22528
    ds_write_b128 v240, v[232:235] offset:23552
    ds_write_b128 v240, v[236:239] offset:24576
    s_waitcnt lgkmcnt(0)
    s_barrier
    buffer_load_dword v6, v5, s[24:27], s49 offen sc1
    ds_write_b128 v240, v[112:115] offset:40960
    ds_write_b128 v240, v[116:119] offset:41984
    ds_write_b128 v240, v[120:123] offset:43008
    ds_write_b128 v240, v[124:127] offset:44032
    ds_write_b128 v240, v[128:131] offset:45056
    ds_write_b128 v241, v[132:135] offset:0
    ds_write_b128 v241, v[136:139] offset:1024
    ds_write_b128 v241, v[140:143] offset:2048
    ds_write_b128 v241, v[144:147] offset:3072
    ds_write_b128 v241, v[148:151] offset:4096
    s_cmp_lg_u32 s7, 0
    s_cbranch_scc1 Lq_44
    buffer_load_dwordx4 v[160:163], v8, s[12:15], s47 offen offset:0
    buffer_load_dwordx4 v[164:167], v9, s[12:15], s47 offen offset:1024
    buffer_load_dwordx4 v[168:171], v10, s[12:15], s47 offen offset:2048
    buffer_load_dwordx4 v[172:175], v11, s[12:15], s47 offen offset:3072
    s_add_u32 s47, s47, 245760
Lq_44:
    s_barrier
    ds_write_b128 v241, v[16:19] offset:20480
    ds_write_b128 v241, v[20:23] offset:21504
    ds_write_b128 v241, v[24:27] offset:22528
    ds_write_b128 v241, v[28:31] offset:23552
    ds_write_b128 v241, v[32:35] offset:24576
    ds_write_b128 v241, v[36:39] offset:40960
    ds_write_b128 v241, v[40:43] offset:41984
    ds_write_b128 v241, v[44:47] offset:43008
    ds_write_b128 v241, v[48:51] offset:44032
    ds_write_b128 v241, v[52:55] offset:45056
    s_cmp_lg_u32 s7, 0
    s_cbranch_scc1 Lq_45
    buffer_load_dwordx4 v[176:179], v8, s[12:15], s47 offen offset:0
    buffer_load_dwordx4 v[180:183], v9, s[12:15], s47 offen offset:1024
    buffer_load_dwordx4 v[184:187], v10, s[12:15], s47 offen offset:2048
    buffer_load_dwordx4 v[188:191], v11, s[12:15], s47 offen offset:3072
    s_add_u32 s47, s47, 245760
    buffer_load_dwordx4 v[192:195], v8, s[12:15], s47 offen offset:0
    buffer_load_dwordx4 v[196:199], v9, s[12:15], s47 offen offset:1024
    buffer_load_dwordx4 v[200:203], v10, s[12:15], s47 offen offset:2048
    buffer_load_dwordx4 v[204:207], v11, s[12:15], s47 offen offset:3072
    s_add_u32 s47, s47, 245760
Lq_45:
    s_waitcnt lgkmcnt(0)
    s_barrier
    s_setprio 0
    s_cmp_eq_u32 s7, 0
    s_cbranch_scc1 Lwb_46
    s_lshl_b32 s44, s5, 2
    s_add_u32 s44, s44, s6
    s_cmp_lg_u32 s44, 0
    s_cbranch_scc1 Lwb_46
    buffer_wbl2 sc1
Lwb_46:
    s_cmp_lg_u32 s7, 0
    s_cbranch_scc1 L_fin
    s_mov_b32 s7, 22331392
    v_and_b32 v13, 31, v1
    s_lshl_b32 s44, s6, 7
    v_lshl_add_u32 v13, v13, 2, s44
    v_lshlrev_b32 v14, 1, v13
    s_lshl_b32 s49, s35, 10
    s_add_u32 s49, s49, 51380224
    v_lshrrev_b32 v15, 5, v1
    v_mul_u32_u24 v15, 81920, v15
    v_add_u32 v15, v15, v14
    s_mov_b32 s44, s49
    buffer_load_dwordx2 v[72:73], v15, s[24:27], s44 offen sc1
    s_add_u32 s44, s44, 16384
    buffer_load_dwordx2 v[74:75], v15, s[24:27], s44 offen sc1
    s_add_u32 s44, s44, 16384
    buffer_load_dwordx2 v[76:77], v15, s[24:27], s44 offen sc1
    s_add_u32 s44, s44, 16384
    buffer_load_dwordx2 v[78:79], v15, s[24:27], s44 offen sc1
    s_add_u32 s44, s44, 16384
    buffer_load_dwordx2 v[80:81], v15, s[24:27], s44 offen sc1
    s_add_u32 s44, s44, 16384
    s_call_b64 s[32:33], S_qw
    s_call_b64 s[32:33], S_qw
    s_lshl_b32 s44, s6, 12
    s_add_u32 s44, s44, 81920
    v_add_u32 v12, s44, v3
    s_waitcnt vmcnt(8)
    s_barrier
    ds_write_b128 v12, v[160:163] offset:0
    ds_write_b128 v12, v[164:167] offset:1024
    ds_write_b128 v12, v[168:171] offset:2048
    ds_write_b128 v12, v[172:175] offset:3072
    ds_write_b128 v12, v[176:179] offset:16384
    ds_write_b128 v12, v[180:183] offset:17408
    ds_write_b128 v12, v[184:187] offset:18432
    ds_write_b128 v12, v[188:191] offset:19456
    s_barrier
    ds_write_b128 v12, v[192:195] offset:32768
    ds_write_b128 v12, v[196:199] offset:33792
    ds_write_b128 v12, v[200:203] offset:34816
    ds_write_b128 v12, v[204:207] offset:35840
    s_mov_b32 s51, s47
    s_mov_b32 s53, 131072
    s_branch L_qkv_l1
L_att_l:
    s_lshl_b32 s79, s2, 2
    s_add_u32 s79, s79, s6
    v_mov_b32 v8, 0
    v_mov_b32 v9, 0
    v_mov_b32 v10, 0
    v_mov_b32 v11, 0
    v_mov_b32 v96, 0
    v_mov_b32 v97, 0
    v_mov_b32 v98, 0
    s_cmp_lg_u32 s7, 0
    s_cbranch_scc1 L_at_nop
    s_cmp_lg_u32 s3, 4
    s_cbranch_scc1 L_at_noxc
    s_lshl_b32 s46, s4, 5
    s_add_u32 s46, s46, s5
    s_lshl_b32 s44, s46, 2
    s_add_u32 s44, s44, s7
    s_add_u32 s44, s44, 3072
    s_mov_b64 exec, 1
    v_mov_b32 v2, s78
    buffer_store_dword v2, off, s[24:27], s44 sc0 sc1
    s_mov_b64 exec, -1
L_at_noxc:
    s_mul_i32 s61, s79, 3277
    s_lshr_b32 s61, s61, 16
    s_mul_i32 s62, s61, 20
    s_sub_u32 s62, s79, s62
    s_lshl_b32 s62, s62, 1
    v_and_b32 v6, 15, v1
    v_lshrrev_b32 v2, 4, v1
    s_lshr_b32 s56, s61, 1
    s_mul_i32 s57, s56, 40
    s_sub_u32 s57, s79, s57
    s_and_b32 s57, s57, 62
    s_lshl_b32 s56, s56, 1
    s_and_b32 s66, s79, 1
    s_add_u32 s56, s56, s66
    v_mul_u32_u24 v96, 24576, v2
    v_lshl_add_u32 v96, v6, 2, v96
    s_mul_i32 s48, s57, 49152
    s_lshl_b32 s66, s56, 6
    s_add_u32 s48, s48, s66
    s_add_u32 s49, s48, 6144
    s_add_u32 s50, s48, 12288
    s_add_u32 s51, s48, 18432
    s_mul_i32 s65, s61, 43
    s_lshr_b32 s65, s65, 7
    s_mul_i32 s65, s65, 3
    s_sub_u32 s65, s61, s65
    s_cmp_eq_u32 s65, 1
    s_mov_b32 s65, 5120
    s_cselect_b32 s65, 10240, s65
    s_mov_b32 s53, 20480
    s_cselect_b32 s53, 5120, s53
    v_and_b32 v5, 1, v2
    v_lshlrev_b32 v5, 2, v5
    v_mul_u32_u24 v7, s65, v2
    v_lshl_add_u32 v97, v6, 2, v7
    s_mul_i32 s52, s61, 40960
    s_lshl_b32 s64, s62, 5
    s_add_u32 s52, s52, s64
    s_add_u32 s53, s53, s52
    v_mad_u32_u24 v5, v4, 20, v5
    v_mad_u32_u24 v7, v2, 40, 16
    s_mul_i32 s65, s61, 52
    s_lshr_b32 s65, s65, 8
    s_mul_i32 s66, s65, 5
    s_sub_u32 s66, s61, s66
    s_mul_i32 s65, s65, 160
    s_cmp_eq_u32 s66, 4
    s_cselect_b64 vcc, -1, 0
    s_cselect_b32 s66, 0, s66
    s_cselect_b32 s55, 20, 8
    s_mul_i32 s66, s66, 40
    s_add_u32 s65, s65, s66
    v_cndmask_b32 v5, v5, v7, vcc
    v_mul_u32_u24 v5, 1280, v5
    v_lshl_add_u32 v98, v6, 2, v5
    s_mul_i32 s54, s65, 1280
    s_add_u32 s54, s54, s64
    s_mul_i32 s55, s55, 1280
    s_add_u32 s55, s55, s54
    v_lshrrev_b32 v5, 3, v6
    v_and_b32 v7, 4, v6
    v_and_b32 v6, 3, v6
    v_lshl_add_u32 v6, v7, 1, v6
    v_and_b32 v7, 1, v2
    v_lshlrev_b32 v8, 11, v5
    v_lshl_add_u32 v8, v2, 8, v8
    v_lshl_add_u32 v8, v6, 4, v8
    v_lshlrev_b32 v9, 7, v5
    v_lshl_add_u32 v9, v4, 6, v9
    v_lshl_add_u32 v9, v6, 2, v9
    v_lshl_add_u32 v9, v7, 4, v9
    v_and_b32 v13, 1, v1
    s_mov_b32 s65, 0x02020202
    v_mul_lo_u32 v13, v13, s65
    v_add_u32 v13, 0x05040100, v13
    s_mul_i32 s65, s56, 43
    s_lshr_b32 s65, s65, 7
    s_mul_i32 s66, s65, 3
    s_sub_u32 s66, s56, s66
    s_lshl_b32 s66, s66, 12
    s_mul_i32 s65, s65, 40
    s_add_u32 s65, s65, s57
    s_mul_i32 s65, s65, 6144
    s_add_u32 s65, s65, s66
    s_add_u32 s73, s65, 44662784
    s_mul_i32 s77, s57, 6144
    s_lshl_b32 s66, s56, 8
    s_add_u32 s77, s77, s66
    s_add_u32 s77, s77, 51642368
    v_add_u32 v5, s62, v5
    v_mul_u32_u24 v7, 52, v5
    v_lshrrev_b32 v7, 8, v7
    v_lshlrev_b32 v5, 10, v5
    v_lshl_add_u32 v5, v2, 8, v5
    v_lshl_add_u32 v5, v6, 4, v5
    v_mul_u32_u24 v10, 240640, v7
    v_add_u32 v10, v10, v5
    v_mul_u32_u24 v11, 97280, v7
    v_add_u32 v11, v11, v5
    s_mul_i32 s74, s61, 5120
    s_add_u32 s75, s74, 48594944
    s_add_u32 s74, s74, 49414144
L_at_nop:
    v_lshlrev_b32 v3, 4, v1
    s_lshl_b32 s67, s6, 12
    s_add_u32 s66, s72, s67
    s_mov_b32 m0, s67
    s_mul_i32 s46, s40, 20
    v_bfe_u32 v5, v1, 4, 1
    v_mad_u32_u24 v5, v5, 19, s46
    v_lshrrev_b32 v5, 7, v5
    v_mad_u32_u24 v6, v4, 5, 5
    v_add_u32 v5, v5, v6
    v_and_b32 v6, 15, v1
    v_lshl_add_u32 v5, v5, 4, v6
    v_lshlrev_b32 v68, 6, v5
    s_waitcnt vmcnt(0)
    s_barrier
    s_cmp_lg_u32 s3, 4
    s_cbranch_scc1 L_at_npl
    s_add_u32 s44, s7, 16384
    s_mov_b32 s45, 0x8000
    s_sleep 12
Lpoll_47:
    buffer_load_dword v64, v68, s[24:27], s44 offen sc1
    s_waitcnt vmcnt(0)
    v_cmp_ne_u32 vcc, s28, v64
    s_sub_u32 s45, s45, 1
    s_cmp_eq_u32 s45, 0
    s_cbranch_scc1 Lpd_48
    s_cmp_lg_u64 vcc, 0
    s_cbranch_scc1 Lpoll_47
Lpd_48:
    s_mov_b64 exec, -1
L_at_npl:
    s_barrier
    buffer_load_dwordx4 v3, s[24:27], s66 offen offset:0 sc1 lds
    buffer_load_dwordx4 v3, s[24:27], s66 offen offset:1024 sc1 lds
    buffer_load_dwordx4 v3, s[24:27], s66 offen offset:2048 sc1 lds
    buffer_load_dwordx4 v3, s[24:27], s66 offen offset:3072 sc1 lds
    s_add_u32 m0, m0, 16384
    s_add_u32 s66, s66, 16384
    buffer_load_dwordx4 v3, s[24:27], s66 offen offset:0 sc1 lds
    buffer_load_dwordx4 v3, s[24:27], s66 offen offset:1024 sc1 lds
    buffer_load_dwordx4 v3, s[24:27], s66 offen offset:2048 sc1 lds
    buffer_load_dwordx4 v3, s[24:27], s66 offen offset:3072 sc1 lds
    s_add_u32 m0, m0, 16384
    s_add_u32 s66, s66, 16384
    s_waitcnt vmcnt(4)
    s_barrier
    buffer_load_dwordx4 v3, s[24:27], s66 offen offset:0 sc1 lds
    buffer_load_dwordx4 v3, s[24:27], s66 offen offset:1024 sc1 lds
    buffer_load_dwordx4 v3, s[24:27], s66 offen offset:2048 sc1 lds
    buffer_load_dwordx4 v3, s[24:27], s66 offen offset:3072 sc1 lds
    s_add_u32 m0, m0, 16384
    s_add_u32 s66, s66, 16384
    buffer_load_dwordx4 v3, s[24:27], s66 offen offset:0 sc1 lds
    buffer_load_dwordx4 v3, s[24:27], s66 offen offset:1024 sc1 lds
    buffer_load_dwordx4 v3, s[24:27], s66 offen offset:2048 sc1 lds
    buffer_load_dwordx4 v3, s[24:27], s66 offen offset:3072 sc1 lds
    s_add_u32 m0, m0, 16384
    s_add_u32 s66, s66, 16384
    buffer_load_dwordx4 v3, s[24:27], s66 offen offset:0 sc1 lds
    buffer_load_dwordx4 v3, s[24:27], s66 offen offset:1024 sc1 lds
    buffer_load_dwordx4 v3, s[24:27], s66 offen offset:2048 sc1 lds
    buffer_load_dwordx4 v3, s[24:27], s66 offen offset:3072 sc1 lds
    s_add_u32 m0, m0, 16384
    s_add_u32 s66, s66, 16384
    buffer_load_dwordx4 v3, s[24:27], s66 offen offset:0 sc1 lds
    buffer_load_dwordx4 v3, s[24:27], s66 offen offset:1024 sc1 lds
    buffer_load_dwordx4 v3, s[24:27], s66 offen offset:2048 sc1 lds
    buffer_load_dwordx4 v3, s[24:27], s66 offen offset:3072 sc1 lds
    s_add_u32 m0, m0, 16384
    s_add_u32 s66, s66, 16384
    s_load_dwordx2 s[60:61], s[0:1], 16
    s_load_dwordx4 s[68:71], s[0:1], 32
    s_load_dwordx2 s[62:63], s[0:1], 48
    s_waitcnt vmcnt(12)
    s_barrier
    buffer_load_dwordx4 v3, s[24:27], s66 offen offset:0 sc1 lds
    buffer_load_dwordx4 v3, s[24:27], s66 offen offset:1024 sc1 lds
    buffer_load_dwordx4 v3, s[24:27], s66 offen offset:2048 sc1 lds
    buffer_load_dwordx4 v3, s[24:27], s66 offen offset:3072 sc1 lds
    s_add_u32 m0, m0, 16384
    s_add_u32 s66, s66, 16384
    buffer_load_dwordx4 v3, s[24:27], s66 offen offset:0 sc1 lds
    buffer_load_dwordx4 v3, s[24:27], s66 offen offset:1024 sc1 lds
    buffer_load_dwordx4 v3, s[24:27], s66 offen offset:2048 sc1 lds
    buffer_load_dwordx4 v3, s[24:27], s66 offen offset:3072 sc1 lds
    s_add_u32 m0, m0, 16384
    s_add_u32 s66, s66, 16384
    buffer_load_dwordx4 v3, s[24:27], s66 offen offset:0 sc1 lds
    buffer_load_dwordx4 v3, s[24:27], s66 offen offset:1024 sc1 lds
    buffer_load_dwordx4 v3, s[24:27], s66 offen offset:2048 sc1 lds
    buffer_load_dwordx4 v3, s[24:27], s66 offen offset:3072 sc1 lds
    s_add_u32 m0, m0, 16384
    s_add_u32 s66, s66, 16384
    buffer_load_dwordx4 v3, s[24:27], s66 offen offset:0 sc1 lds
    buffer_load_dwordx4 v3, s[24:27], s66 offen offset:1024 sc1 lds
    buffer_load_dwordx4 v3, s[24:27], s66 offen offset:2048 sc1 lds
    buffer_load_dwordx4 v3, s[24:27], s66 offen offset:3072 sc1 lds
    s_add_u32 m0, m0, 16384
    s_add_u32 s66, s66, 16384
    s_lshl_b32 s64, s6, 2
    v_mov_b32 v4, s64
    v_mov_b32 v5, s28
    s_waitcnt vmcnt(0) lgkmcnt(0)
    ds_write_b32 v4, v5 offset:4096
    s_setprio 3
    s_cmp_lg_u32 s7, 0
    s_cbranch_scc1 L_at_l2
    s_cmp_ge_u32 s79, 960
    s_cbranch_scc1 L_at_lp3
    s_mov_b32 s20, s68
    s_mov_b32 s21, s69
    s_mov_b32 s22, 1966080
    s_mov_b32 s23, 0x00020000
    buffer_load_dword v64, v96, s[20:23], s48 offen offset:0
    buffer_load_dword v65, v96, s[20:23], s48 offen offset:3072
    buffer_load_dword v66, v96, s[20:23], s49 offen offset:0
    buffer_load_dword v67, v96, s[20:23], s49 offen offset:3072
    buffer_load_dword v68, v96, s[20:23], s50 offen offset:0
    buffer_load_dword v69, v96, s[20:23], s50 offen offset:3072
    buffer_load_dword v70, v96, s[20:23], s51 offen offset:0
    buffer_load_dword v71, v96, s[20:23], s51 offen offset:3072
    s_mov_b32 s20, s70
    s_mov_b32 s21, s71
    s_mov_b32 s22, 1966080
    s_mov_b32 s23, 0x00020000
    buffer_load_dword v72, v96, s[20:23], s48 offen offset:0
    buffer_load_dword v73, v96, s[20:23], s48 offen offset:3072
    buffer_load_dword v74, v96, s[20:23], s49 offen offset:0
    buffer_load_dword v75, v96, s[20:23], s49 offen offset:3072
    buffer_load_dword v76, v96, s[20:23], s50 offen offset:0
    buffer_load_dword v77, v96, s[20:23], s50 offen offset:3072
    buffer_load_dword v78, v96, s[20:23], s51 offen offset:0
    buffer_load_dword v79, v96, s[20:23], s51 offen offset:3072
    s_mov_b32 s20, s62
    s_mov_b32 s21, s63
    s_mov_b32 s22, 1966080
    s_mov_b32 s23, 0x00020000
    buffer_load_dword v80, v97, s[20:23], s52 offen offset:0
    buffer_load_dword v81, v97, s[20:23], s52 offen offset:1280
    buffer_load_dword v82, v97, s[20:23], s52 offen offset:2560
    buffer_load_dword v83, v97, s[20:23], s52 offen offset:3840
    buffer_load_dword v84, v97, s[20:23], s53 offen offset:0
    buffer_load_dword v85, v97, s[20:23], s53 offen offset:1280
    buffer_load_dword v86, v97, s[20:23], s53 offen offset:2560
    buffer_load_dword v87, v97, s[20:23], s53 offen offset:3840
    s_mov_b32 s20, s60
    s_mov_b32 s21, s61
    s_mov_b32 s22, 819200
    s_mov_b32 s23, 0x00020000
    buffer_load_dword v88, v98, s[20:23], s54 offen offset:0
    buffer_load_dword v89, v98, s[20:23], s54 offen offset:1280
    buffer_load_dword v90, v98, s[20:23], s54 offen offset:2560
    buffer_load_dword v91, v98, s[20:23], s54 offen offset:3840
    buffer_load_dword v92, v98, s[20:23], s55 offen offset:0
    buffer_load_dword v93, v98, s[20:23], s55 offen offset:1280
    buffer_load_dword v94, v98, s[20:23], s55 offen offset:2560
    buffer_load_dword v95, v98, s[20:23], s55 offen offset:3840
    s_mov_b32 s61, 0x3f803f80
    s_waitcnt vmcnt(24)
    v_mov_b32_dpp v14, v64 quad_perm:[0,0,1,1] row_mask:0xf bank_mask:0xf
    v_mov_b32_dpp v15, v65 quad_perm:[0,0,1,1] row_mask:0xf bank_mask:0xf
    v_perm_b32 v96, v15, v14, v13
    v_mov_b32_dpp v14, v66 quad_perm:[0,0,1,1] row_mask:0xf bank_mask:0xf
    v_mov_b32_dpp v15, v67 quad_perm:[0,0,1,1] row_mask:0xf bank_mask:0xf
    v_perm_b32 v97, v15, v14, v13
    v_mov_b32_dpp v14, v68 quad_perm:[0,0,1,1] row_mask:0xf bank_mask:0xf
    v_mov_b32_dpp v15, v69 quad_perm:[0,0,1,1] row_mask:0xf bank_mask:0xf
    v_perm_b32 v98, v15, v14, v13
    v_mov_b32_dpp v14, v70 quad_perm:[0,0,1,1] row_mask:0xf bank_mask:0xf
    v_mov_b32_dpp v15, v71 quad_perm:[0,0,1,1] row_mask:0xf bank_mask:0xf
    v_perm_b32 v99, v15, v14, v13
    buffer_store_dwordx4 v[96:99], v8, s[24:27], s73 offen offset:0 sc1
    v_mov_b32_dpp v14, v64 quad_perm:[2,2,3,3] row_mask:0xf bank_mask:0xf
    v_mov_b32_dpp v15, v65 quad_perm:[2,2,3,3] row_mask:0xf bank_mask:0xf
    v_perm_b32 v100, v15, v14, v13
    v_mov_b32_dpp v14, v66 quad_perm:[2,2,3,3] row_mask:0xf bank_mask:0xf
    v_mov_b32_dpp v15, v67 quad_perm:[2,2,3,3] row_mask:0xf bank_mask:0xf
    v_perm_b32 v101, v15, v14, v13
    v_mov_b32_dpp v14, v68 quad_perm:[2,2,3,3] row_mask:0xf bank_mask:0xf
    v_mov_b32_dpp v15, v69 quad_perm:[2,2,3,3] row_mask:0xf bank_mask:0xf
    v_perm_b32 v102, v15, v14, v13
    v_mov_b32_dpp v14, v70 quad_perm:[2,2,3,3] row_mask:0xf bank_mask:0xf
    v_mov_b32_dpp v15, v71 quad_perm:[2,2,3,3] row_mask:0xf bank_mask:0xf
    v_perm_b32 v103, v15, v14, v13
    buffer_store_dwordx4 v[100:103], v8, s[24:27], s73 offen offset:64 sc1
    v_dot2_f32_bf16 v104, v96, s61, 0
    v_dot2_f32_bf16 v104, v97, s61, v104
    v_dot2_f32_bf16 v104, v98, s61, v104
    v_dot2_f32_bf16 v104, v99, s61, v104
    v_dot2_f32_bf16 v106, v100, s61, 0
    v_dot2_f32_bf16 v106, v101, s61, v106
    v_dot2_f32_bf16 v106, v102, s61, v106
    v_dot2_f32_bf16 v106, v103, s61, v106
    s_waitcnt vmcnt(18)
    v_mov_b32_dpp v14, v72 quad_perm:[0,0,1,1] row_mask:0xf bank_mask:0xf
    v_mov_b32_dpp v15, v73 quad_perm:[0,0,1,1] row_mask:0xf bank_mask:0xf
    v_perm_b32 v96, v15, v14, v13
    v_mov_b32_dpp v14, v74 quad_perm:[0,0,1,1] row_mask:0xf bank_mask:0xf
    v_mov_b32_dpp v15, v75 quad_perm:[0,0,1,1] row_mask:0xf bank_mask:0xf
    v_perm_b32 v97, v15, v14, v13
    v_mov_b32_dpp v14, v76 quad_perm:[0,0,1,1] row_mask:0xf bank_mask:0xf
    v_mov_b32_dpp v15, v77 quad_perm:[0,0,1,1] row_mask:0xf bank_mask:0xf
    v_perm_b32 v98, v15, v14, v13
    v_mov_b32_dpp v14, v78 quad_perm:[0,0,1,1] row_mask:0xf bank_mask:0xf
    v_mov_b32_dpp v15, v79 quad_perm:[0,0,1,1] row_mask:0xf bank_mask:0xf
    v_perm_b32 v99, v15, v14, v13
    buffer_store_dwordx4 v[96:99], v8, s[24:27], s73 offen offset:1024 sc1
    v_mov_b32_dpp v14, v72 quad_perm:[2,2,3,3] row_mask:0xf bank_mask:0xf
    v_mov_b32_dpp v15, v73 quad_perm:[2,2,3,3] row_mask:0xf bank_mask:0xf
    v_perm_b32 v100, v15, v14, v13
    v_mov_b32_dpp v14, v74 quad_perm:[2,2,3,3] row_mask:0xf bank_mask:0xf
    v_mov_b32_dpp v15, v75 quad_perm:[2,2,3,3] row_mask:0xf bank_mask:0xf
    v_perm_b32 v101, v15, v14, v13
    v_mov_b32_dpp v14, v76 quad_perm:[2,2,3,3] row_mask:0xf bank_mask:0xf
    v_mov_b32_dpp v15, v77 quad_perm:[2,2,3,3] row_mask:0xf bank_mask:0xf
    v_perm_b32 v102, v15, v14, v13
    v_mov_b32_dpp v14, v78 quad_perm:[2,2,3,3] row_mask:0xf bank_mask:0xf
    v_mov_b32_dpp v15, v79 quad_perm:[2,2,3,3] row_mask:0xf bank_mask:0xf
    v_perm_b32 v103, v15, v14, v13
    buffer_store_dwordx4 v[100:103], v8, s[24:27], s73 offen offset:1088 sc1
    v_dot2_f32_bf16 v105, v96, s61, 0
    v_dot2_f32_bf16 v105, v97, s61, v105
    v_dot2_f32_bf16 v105, v98, s61, v105
    v_dot2_f32_bf16 v105, v99, s61, v105
    v_dot2_f32_bf16 v107, v100, s61, 0
    v_dot2_f32_bf16 v107, v101, s61, v107
    v_dot2_f32_bf16 v107, v102, s61, v107
    v_dot2_f32_bf16 v107, v103, s61, v107
    s_waitcnt vmcnt(12)
    v_mov_b32_dpp v14, v80 quad_perm:[0,0,1,1] row_mask:0xf bank_mask:0xf
    v_mov_b32_dpp v15, v81 quad_perm:[0,0,1,1] row_mask:0xf bank_mask:0xf
    v_perm_b32 v96, v15, v14, v13
    v_mov_b32_dpp v14, v82 quad_perm:[0,0,1,1] row_mask:0xf bank_mask:0xf
    v_mov_b32_dpp v15, v83 quad_perm:[0,0,1,1] row_mask:0xf bank_mask:0xf
    v_perm_b32 v97, v15, v14, v13
    v_mov_b32_dpp v14, v84 quad_perm:[0,0,1,1] row_mask:0xf bank_mask:0xf
    v_mov_b32_dpp v15, v85 quad_perm:[0,0,1,1] row_mask:0xf bank_mask:0xf
    v_perm_b32 v98, v15, v14, v13
    v_mov_b32_dpp v14, v86 quad_perm:[0,0,1,1] row_mask:0xf bank_mask:0xf
    v_mov_b32_dpp v15, v87 quad_perm:[0,0,1,1] row_mask:0xf bank_mask:0xf
    v_perm_b32 v99, v15, v14, v13
    buffer_store_dwordx4 v[96:99], v10, s[24:27], s74 offen offset:0 sc1
    v_mov_b32_dpp v14, v80 quad_perm:[2,2,3,3] row_mask:0xf bank_mask:0xf
    v_mov_b32_dpp v15, v81 quad_perm:[2,2,3,3] row_mask:0xf bank_mask:0xf
    v_perm_b32 v100, v15, v14, v13
    v_mov_b32_dpp v14, v82 quad_perm:[2,2,3,3] row_mask:0xf bank_mask:0xf
    v_mov_b32_dpp v15, v83 quad_perm:[2,2,3,3] row_mask:0xf bank_mask:0xf
    v_perm_b32 v101, v15, v14, v13
    v_mov_b32_dpp v14, v84 quad_perm:[2,2,3,3] row_mask:0xf bank_mask:0xf
    v_mov_b32_dpp v15, v85 quad_perm:[2,2,3,3] row_mask:0xf bank_mask:0xf
    v_perm_b32 v102, v15, v14, v13
    v_mov_b32_dpp v14, v86 quad_perm:[2,2,3,3] row_mask:0xf bank_mask:0xf
    v_mov_b32_dpp v15, v87 quad_perm:[2,2,3,3] row_mask:0xf bank_mask:0xf
    v_perm_b32 v103, v15, v14, v13
    buffer_store_dwordx4 v[100:103], v10, s[24:27], s74 offen offset:64 sc1
    v_permlane32_swap_b32 v104, v105
    v_permlane32_swap_b32 v106, v107
    s_nop 0
    v_add_f32 v104, v104, v105
    v_add_f32 v106, v106, v107
    s_nop 1
    v_permlane16_swap_b32 v104, v106
    s_nop 0
    v_add_f32 v104, v104, v106
    buffer_store_dword v104, v9, s[24:27], s77 offen sc1
    s_cmp_ge_u32 s79, 400
    s_cbranch_scc1 L_at_lp3
    s_waitcnt vmcnt(7)
    v_mov_b32_dpp v14, v88 quad_perm:[0,0,1,1] row_mask:0xf bank_mask:0xf
    v_mov_b32_dpp v15, v89 quad_perm:[0,0,1,1] row_mask:0xf bank_mask:0xf
    v_perm_b32 v96, v15, v14, v13
    v_mov_b32_dpp v14, v90 quad_perm:[0,0,1,1] row_mask:0xf bank_mask:0xf
    v_mov_b32_dpp v15, v91 quad_perm:[0,0,1,1] row_mask:0xf bank_mask:0xf
    v_perm_b32 v97, v15, v14, v13
    v_mov_b32_dpp v14, v92 quad_perm:[0,0,1,1] row_mask:0xf bank_mask:0xf
    v_mov_b32_dpp v15, v93 quad_perm:[0,0,1,1] row_mask:0xf bank_mask:0xf
    v_perm_b32 v98, v15, v14, v13
    v_mov_b32_dpp v14, v94 quad_perm:[0,0,1,1] row_mask:0xf bank_mask:0xf
    v_mov_b32_dpp v15, v95 quad_perm:[0,0,1,1] row_mask:0xf bank_mask:0xf
    v_perm_b32 v99, v15, v14, v13
    buffer_store_dwordx4 v[96:99], v11, s[24:27], s75 offen offset:0 sc1
    v_mov_b32_dpp v14, v88 quad_perm:[2,2,3,3] row_mask:0xf bank_mask:0xf
    v_mov_b32_dpp v15, v89 quad_perm:[2,2,3,3] row_mask:0xf bank_mask:0xf
    v_perm_b32 v100, v15, v14, v13
    v_mov_b32_dpp v14, v90 quad_perm:[2,2,3,3] row_mask:0xf bank_mask:0xf
    v_mov_b32_dpp v15, v91 quad_perm:[2,2,3,3] row_mask:0xf bank_mask:0xf
    v_perm_b32 v101, v15, v14, v13
    v_mov_b32_dpp v14, v92 quad_perm:[2,2,3,3] row_mask:0xf bank_mask:0xf
    v_mov_b32_dpp v15, v93 quad_perm:[2,2,3,3] row_mask:0xf bank_mask:0xf
    v_perm_b32 v102, v15, v14, v13
    v_mov_b32_dpp v14, v94 quad_perm:[2,2,3,3] row_mask:0xf bank_mask:0xf
    v_mov_b32_dpp v15, v95 quad_perm:[2,2,3,3] row_mask:0xf bank_mask:0xf
    v_perm_b32 v103, v15, v14, v13
    buffer_store_dwordx4 v[100:103], v11, s[24:27], s75 offen offset:64 sc1
L_at_lp3:
    s_waitcnt vmcnt(0)
    s_lshl_b32 s44, s79, 2
    s_add_u32 s44, s44, s7
    s_add_u32 s44, s44, 8192
    s_mov_b64 exec, 1
    v_mov_b32 v2, s28
    buffer_store_dword v2, off, s[24:27], s44 sc0 sc1
    s_mov_b64 exec, -1
    s_lshl_b32 s44, s4, 7
    s_add_u32 s44, s44, 3072
    v_lshlrev_b32 v64, 2, v1
    s_mov_b32 exec_hi, 0
    s_mov_b32 s45, 0x8000
Lxc_49:
    buffer_load_dword v65, v64, s[24:27], s44 offen sc1
    s_waitcnt vmcnt(0)
    v_xor_b32 v65, s78, v65
    v_cmp_lt_u32 vcc, 7, v65
    s_sub_u32 s45, s45, 1
    s_cmp_eq_u32 s45, 0
    s_cbranch_scc1 Lxc_50
    s_cmp_lg_u64 vcc, 0
    s_cbranch_scc1 Lxc_49
Lxc_50:
    v_cmp_ne_u32 vcc, 0, v65
    s_mov_b64 exec, -1
    s_nop 0
    s_cmp_eq_u64 vcc, 0
    s_cselect_b32 s29, 1, 0
    s_mul_i32 s46, s39, 3
    s_lshr_b32 s46, s46, 1
    s_mul_i32 s46, s46, 40
    s_mov_b64 exec, 0xfffff
    s_lshl_b32 s44, s46, 2
    s_add_u32 s44, s44, s7
    s_add_u32 s44, s44, 8192
    v_lshlrev_b32 v68, 4, v1
    s_mov_b32 s45, 0x8000
    s_branch Lpf_53
Lpoll_51:
    s_sleep 16
Lpf_53:
    buffer_load_dwordx4 v[64:67], v68, s[24:27], s44 offen sc1
    s_waitcnt vmcnt(0)
    v_xor_b32 v64, s28, v64
    v_xor_b32 v65, s28, v65
    v_xor_b32 v66, s28, v66
    v_xor_b32 v67, s28, v67
    v_or3_b32 v64, v64, v65, v66
    v_or_b32 v64, v64, v67
    v_cmp_lt_u32 vcc, 7, v64
    s_sub_u32 s45, s45, 1
    s_cmp_eq_u32 s45, 0
    s_cbranch_scc1 Lpd_52
    s_cmp_lg_u64 vcc, 0
    s_cbranch_scc1 Lpoll_51
Lpd_52:
    s_mov_b64 exec, -1
    v_min_u32 v12, 47, v1
    s_mul_i32 s44, s6, 192
    v_lshl_add_u32 v12, v12, 2, s44
    s_mul_i32 s44, s39, 768
    s_add_u32 s44, s44, 51642368
    buffer_load_dword v200, v12, s[24:27], s44 offen sc1
    s_add_u32 s44, s44, 12288
    buffer_load_dword v201, v12, s[24:27], s44 offen sc1
    s_add_u32 s44, s44, 12288
    buffer_load_dword v202, v12, s[24:27], s44 offen sc1
    s_add_u32 s44, s44, 12288
    buffer_load_dword v203, v12, s[24:27], s44 offen sc1
    s_add_u32 s44, s44, 12288
    buffer_load_dword v204, v12, s[24:27], s44 offen sc1
    s_add_u32 s44, s44, 12288
    buffer_load_dword v205, v12, s[24:27], s44 offen sc1
    s_add_u32 s44, s44, 12288
    buffer_load_dword v206, v12, s[24:27], s44 offen sc1
    s_add_u32 s44, s44, 12288
    buffer_load_dword v207, v12, s[24:27], s44 offen sc1
    s_add_u32 s44, s44, 12288
    buffer_load_dword v208, v12, s[24:27], s44 offen sc1
    s_add_u32 s44, s44, 12288
    buffer_load_dword v209, v12, s[24:27], s44 offen sc1
    s_add_u32 s44, s44, 12288
    buffer_load_dword v210, v12, s[24:27], s44 offen sc1
    s_add_u32 s44, s44, 12288
    buffer_load_dword v211, v12, s[24:27], s44 offen sc1
    s_add_u32 s44, s44, 12288
    buffer_load_dword v212, v12, s[24:27], s44 offen sc1
    s_add_u32 s44, s44, 12288
    buffer_load_dword v213, v12, s[24:27], s44 offen sc1
    s_add_u32 s44, s44, 12288
    buffer_load_dword v214, v12, s[24:27], s44 offen sc1
    s_add_u32 s44, s44, 12288
    buffer_load_dword v215, v12, s[24:27], s44 offen sc1
    s_add_u32 s44, s44, 12288
    buffer_load_dword v216, v12, s[24:27], s44 offen sc1
    s_add_u32 s44, s44, 12288
    buffer_load_dword v217, v12, s[24:27], s44 offen sc1
    s_add_u32 s44, s44, 12288
    buffer_load_dword v218, v12, s[24:27], s44 offen sc1
    s_add_u32 s44, s44, 12288
    buffer_load_dword v219, v12, s[24:27], s44 offen sc1
    s_add_u32 s44, s44, 12288
L_at_l2:
    s_cmp_eq_u32 s7, 0
    s_cbranch_scc1 Lwb_54
    s_lshl_b32 s44, s5, 2
    s_add_u32 s44, s44, s6
    s_cmp_lg_u32 s44, 0
    s_cbranch_scc1 Lwb_54
    buffer_wbl2 sc1
Lwb_54:
    s_mul_i32 s51, s39, 40
    s_add_u32 s51, s51, s6
    s_mul_i32 s51, s51, 6144
    s_add_u32 s51, s51, 44662784
    buffer_load_dwordx4 v[16:19], v3, s[24:27], s51 offen offset:0 sc1
    buffer_load_dwordx4 v[20:23], v3, s[24:27], s51 offen offset:1024 sc1
    buffer_load_dwordx4 v[24:27], v3, s[24:27], s51 offen offset:2048 sc1
    buffer_load_dwordx4 v[28:31], v3, s[24:27], s51 offen offset:3072 sc1
    s_add_u32 s51, s51, 4096
    buffer_load_dwordx4 v[32:35], v3, s[24:27], s51 offen offset:0 sc1
    buffer_load_dwordx4 v[36:39], v3, s[24:27], s51 offen offset:1024 sc1
    s_add_u32 s51, s51, 20480
    buffer_load_dwordx4 v[40:43], v3, s[24:27], s51 offen offset:0 sc1
    buffer_load_dwordx4 v[44:47], v3, s[24:27], s51 offen offset:1024 sc1
    buffer_load_dwordx4 v[48:51], v3, s[24:27], s51 offen offset:2048 sc1
    buffer_load_dwordx4 v[52:55], v3, s[24:27], s51 offen offset:3072 sc1
    s_add_u32 s51, s51, 4096
    buffer_load_dwordx4 v[56:59], v3, s[24:27], s51 offen offset:0 sc1
    buffer_load_dwordx4 v[60:63], v3, s[24:27], s51 offen offset:1024 sc1
    s_add_u32 s51, s51, 20480
    buffer_load_dwordx4 v[64:67], v3, s[24:27], s51 offen offset:0 sc1
    buffer_load_dwordx4 v[68:71], v3, s[24:27], s51 offen offset:1024 sc1
    buffer_load_dwordx4 v[72:75], v3, s[24:27], s51 offen offset:2048 sc1
    buffer_load_dwordx4 v[76:79], v3, s[24:27], s51 offen offset:3072 sc1
    s_add_u32 s51, s51, 4096
    buffer_load_dwordx4 v[80:83], v3, s[24:27], s51 offen offset:0 sc1
    buffer_load_dwordx4 v[84:87], v3, s[24:27], s51 offen offset:1024 sc1
    s_add_u32 s51, s51, 20480
    buffer_load_dwordx4 v[88:91], v3, s[24:27], s51 offen offset:0 sc1
    buffer_load_dwordx4 v[92:95], v3, s[24:27], s51 offen offset:1024 sc1
    buffer_load_dwordx4 v[96:99], v3, s[24:27], s51 offen offset:2048 sc1
    buffer_load_dwordx4 v[100:103], v3, s[24:27], s51 offen offset:3072 sc1
    s_add_u32 s51, s51, 4096
    buffer_load_dwordx4 v[104:107], v3, s[24:27], s51 offen offset:0 sc1
    buffer_load_dwordx4 v[108:111], v3, s[24:27], s51 offen offset:1024 sc1
    s_add_u32 s51, s51, 20480
    s_cmp_eq_u32 s7, 0
    s_cbranch_scc1 L_at_l3
    s_call_b64 s[32:33], S_tl
    s_call_b64 s[32:33], S_t45
    s_branch L_at_ppe
L_at_l3:
    s_mov_b32 s44, 8192
    s_mov_b32 s45, 0x4000
L_at_pp:
    buffer_load_dwordx4 v[160:163], v3, s[24:27], s44 offen offset:0 sc1
    buffer_load_dwordx4 v[164:167], v3, s[24:27], s44 offen offset:1024 sc1
    buffer_load_dwordx4 v[168:171], v3, s[24:27], s44 offen offset:2048 sc1
    buffer_load_dwordx4 v[172:175], v3, s[24:27], s44 offen offset:3072 sc1
    s_waitcnt vmcnt(0)
    v_min3_u32 v180, v160, v161, v161
    v_max3_u32 v181, v160, v161, v161
    v_min3_u32 v180, v180, v162, v163
    v_max3_u32 v181, v181, v162, v163
    v_min3_u32 v180, v180, v164, v165
    v_max3_u32 v181, v181, v164, v165
    v_min3_u32 v180, v180, v166, v167
    v_max3_u32 v181, v181, v166, v167
    v_min3_u32 v180, v180, v168, v169
    v_max3_u32 v181, v181, v168, v169
    v_min3_u32 v180, v180, v170, v171
    v_max3_u32 v181, v181, v170, v171
    v_min3_u32 v180, v180, v172, v173
    v_max3_u32 v181, v181, v172, v173
    v_min3_u32 v180, v180, v174, v175
    v_max3_u32 v181, v181, v174, v175
    v_cmp_ne_u32 vcc, s28, v180
    v_cmp_ne_u32 s[60:61], s28, v181
    s_sub_u32 s45, s45, 1
    s_cmp_eq_u32 s45, 0
    s_cbranch_scc1 L_at_ppd
    s_or_b64 vcc, vcc, s[60:61]
    s_cbranch_scc0 L_at_ppd
    s_sleep 24
    s_branch L_at_pp
L_at_ppd:
    v_add_f32 v248, v200, v201
    v_add_f32 v248, v248, v202
    v_add_f32 v248, v248, v203
    v_add_f32 v248, v248, v204
    v_add_f32 v248, v248, v205
    v_add_f32 v248, v248, v206
    v_add_f32 v248, v248, v207
    v_add_f32 v248, v248, v208
    v_add_f32 v248, v248, v209
    v_add_f32 v248, v248, v210
    v_add_f32 v248, v248, v211
    v_add_f32 v248, v248, v212
    v_add_f32 v248, v248, v213
    v_add_f32 v248, v248, v214
    v_add_f32 v248, v248, v215
    v_add_f32 v248, v248, v216
    v_add_f32 v248, v248, v217
    v_add_f32 v248, v248, v218
    v_add_f32 v248, v248, v219
L_at_ppe:
    s_cmp_eq_u32 s7, 0
    s_cbranch_scc1 L_at_l5
    s_and_b32 s61, s5, 1
    s_lshl_b32 s61, s61, 2
    s_add_u32 s61, s61, s6
    s_lshl_b32 s62, s61, 13
    s_mul_i32 s60, s39, 245760
    s_add_u32 s60, s60, s62
    s_add_u32 s60, s60, 44761088
    v_lshlrev_b32 v8, 7, v1
    buffer_load_dword v10, v8, s[24:27], s60 offen sc1
    s_add_u32 s60, s60, 65536
    buffer_load_dword v10, v8, s[24:27], s60 offen sc1
    s_add_u32 s60, s60, 65536
    s_cmp_lt_u32 s61, 2
    s_cselect_b32 s60, s60, 51888128
    buffer_load_dword v10, v8, s[24:27], s60 offen sc1
    s_add_u32 s60, s60, 65536
    s_call_b64 s[32:33], S_wot
    s_call_b64 s[32:33], S_pv
    s_branch L_at_l6
L_at_l5:
    s_call_b64 s[32:33], S_pv
    s_call_b64 s[32:33], S_wot
    s_lshl_b32 s62, s5, 2
    s_add_u32 s62, s62, s6
    s_lshl_b32 s62, s62, 8
    v_lshl_add_u32 v8, v1, 2, s62
    v_min_u32 v8, 0x7ba0, v8
    global_load_dword v10, v8, s[90:91]
L_at_l6:
    s_setprio 0
    s_waitcnt vmcnt(0)
    s_barrier
    s_cmp_lg_u32 s7, 0
    s_cbranch_scc1 L_wo_l
    s_call_b64 s[32:33], S_tl
    s_branch L_wo_l
L_fin:
L_exit:
    s_endpgm
S_gl:
    s_mov_b32 s44, s49
    buffer_load_dwordx2 v[72:73], v15, s[24:27], s44 offen sc1
    s_add_u32 s44, s44, 16384
    buffer_load_dwordx2 v[74:75], v15, s[24:27], s44 offen sc1
    s_add_u32 s44, s44, 16384
    buffer_load_dwordx2 v[76:77], v15, s[24:27], s44 offen sc1
    s_add_u32 s44, s44, 16384
    buffer_load_dwordx2 v[78:79], v15, s[24:27], s44 offen sc1
    s_add_u32 s44, s44, 16384
    buffer_load_dwordx2 v[80:81], v15, s[24:27], s44 offen sc1
    s_add_u32 s44, s44, 16384
    s_mov_b32 s44, s48
    buffer_load_dwordx4 v[84:87], v133, s[24:27], s44 offen sc1
    s_add_u32 s44, s44, 32768
    buffer_load_dwordx4 v[88:91], v133, s[24:27], s44 offen sc1
    s_add_u32 s44, s44, 32768
    buffer_load_dwordx4 v[92:95], v133, s[24:27], s44 offen sc1
    s_add_u32 s44, s44, 32768
    buffer_load_dwordx4 v[96:99], v133, s[24:27], s44 offen sc1
    s_add_u32 s44, s44, 32768
    buffer_load_dwordx4 v[100:103], v133, s[24:27], s44 offen sc1
    s_add_u32 s44, s44, 32768
    s_setpc_b64 s[32:33]
L_at_slow:
    s_mov_b32 s63, 2
    s_waitcnt lgkmcnt(0)
L_at_sl0:
    s_waitcnt vmcnt(0)
    v_mov_b32 v190, 0xff800000
    s_mov_b32 s60, s72
    s_mov_b32 s61, 32
L_at_mx:
    buffer_load_dwordx2 v[20:21], v186, s[24:27], s60 offen offset:2048 sc1
    buffer_load_dwordx2 v[136:137], v186, s[24:27], s60 offen offset:0 sc1
    buffer_load_dwordx2 v[138:139], v186, s[24:27], s60 offen offset:512 sc1
    buffer_load_dwordx2 v[140:141], v186, s[24:27], s60 offen offset:1024 sc1
    buffer_load_dwordx2 v[142:143], v186, s[24:27], s60 offen offset:1536 sc1
    s_waitcnt vmcnt(0)
    v_mfma_f32_32x32x4_2b_bf16 v[24:55], v[20:21], v[16:17], 0
    s_nop 15
    s_nop 1
    v_mfma_f32_32x32x16_bf16 v[24:39], v[136:139], v[8:11], v[24:39]
    v_mfma_f32_32x32x16_bf16 v[40:55], v[140:143], v[8:11], v[40:55]
    s_nop 11
    v_max3_f32 v190, v190, v24, v25
    v_max3_f32 v190, v190, v26, v27
    v_max3_f32 v190, v190, v28, v29
    v_max3_f32 v190, v190, v30, v31
    v_max3_f32 v190, v190, v32, v33
    v_max3_f32 v190, v190, v34, v35
    v_max3_f32 v190, v190, v36, v37
    v_max3_f32 v190, v190, v38, v39
    v_max3_f32 v190, v190, v40, v41
    v_max3_f32 v190, v190, v42, v43
    v_max3_f32 v190, v190, v44, v45
    v_max3_f32 v190, v190, v46, v47
    v_max3_f32 v190, v190, v48, v49
    v_max3_f32 v190, v190, v50, v51
    v_max3_f32 v190, v190, v52, v53
    v_max3_f32 v190, v190, v54, v55
    s_add_u32 s60, s60, 5120
    s_sub_u32 s61, s61, 1
    s_cmp_lg_u32 s61, 0
    s_cbranch_scc1 L_at_mx
    v_mov_b32 v191, v190
    s_nop 1
    v_permlane32_swap_b32 v190, v191
    s_nop 1
    v_max_f32 v190, v190, v191
    v_sub_f32 v56, 0, v190
    v_sub_f32 v57, 0, v190
    v_sub_f32 v58, 0, v190
    v_sub_f32 v59, 0, v190
    v_sub_f32 v60, 0, v190
    v_sub_f32 v61, 0, v190
    v_sub_f32 v62, 0, v190
    v_sub_f32 v63, 0, v190
    v_sub_f32 v64, 0, v190
    v_sub_f32 v65, 0, v190
    v_sub_f32 v66, 0, v190
    v_sub_f32 v67, 0, v190
    v_sub_f32 v68, 0, v190
    v_sub_f32 v69, 0, v190
    v_sub_f32 v70, 0, v190
    v_sub_f32 v71, 0, v190
    v_sub_f32 v72, 0, v190
    v_sub_f32 v73, 0, v190
    v_sub_f32 v74, 0, v190
    v_sub_f32 v75, 0, v190
    v_sub_f32 v76, 0, v190
    v_sub_f32 v77, 0, v190
    v_sub_f32 v78, 0, v190
    v_sub_f32 v79, 0, v190
    v_sub_f32 v80, 0, v190
    v_sub_f32 v81, 0, v190
    v_sub_f32 v82, 0, v190
    v_sub_f32 v83, 0, v190
    v_sub_f32 v84, 0, v190
    v_sub_f32 v85, 0, v190
    v_sub_f32 v86, 0, v190
    v_sub_f32 v87, 0, v190
    v_mov_b32 v104, 0
    v_mov_b32 v105, 0
    v_mov_b32 v106, 0
    v_mov_b32 v107, 0
    v_mov_b32 v108, 0
    v_mov_b32 v109, 0
    v_mov_b32 v110, 0
    v_mov_b32 v111, 0
    v_mov_b32 v112, 0
    v_mov_b32 v113, 0
    v_mov_b32 v114, 0
    v_mov_b32 v115, 0
    v_mov_b32 v116, 0
    v_mov_b32 v117, 0
    v_mov_b32 v118, 0
    v_mov_b32 v119, 0
    s_mov_b32 s60, s72
    s_mov_b32 s61, 32
L_at_sl2:
    buffer_load_dwordx2 v[20:21], v186, s[24:27], s60 offen offset:2048 sc1
    buffer_load_dwordx2 v[136:137], v186, s[24:27], s60 offen offset:0 sc1
    buffer_load_dwordx2 v[138:139], v186, s[24:27], s60 offen offset:512 sc1
    buffer_load_dwordx2 v[140:141], v186, s[24:27], s60 offen offset:1024 sc1
    buffer_load_dwordx2 v[142:143], v186, s[24:27], s60 offen offset:1536 sc1
    s_mov_b64 exec, s[42:43]
    buffer_load_dwordx4 v[152:155], v187, s[24:27], s60 offen offset:0 sc1
    buffer_load_dwordx4 v[156:159], v187, s[24:27], s60 offen offset:640 sc1
    buffer_load_dwordx4 v[160:163], v187, s[24:27], s60 offen offset:1280 sc1
    buffer_load_dwordx4 v[164:167], v187, s[24:27], s60 offen offset:1920 sc1
    s_mov_b64 exec, -1
    s_waitcnt vmcnt(0)
    v_mfma_f32_32x32x4_2b_bf16 v[24:55], v[20:21], v[16:17], v[56:87]
    s_nop 15
    s_nop 1
    v_mfma_f32_32x32x16_bf16 v[24:39], v[136:139], v[8:11], v[24:39]
    v_mfma_f32_32x32x16_bf16 v[40:55], v[140:143], v[8:11], v[40:55]
    s_nop 11
    v_exp_f32 v24, v24
    v_exp_f32 v25, v25
    v_exp_f32 v26, v26
    v_exp_f32 v27, v27
    v_exp_f32 v28, v28
    v_exp_f32 v29, v29
    v_exp_f32 v30, v30
    v_exp_f32 v31, v31
    v_exp_f32 v32, v32
    v_exp_f32 v33, v33
    v_exp_f32 v34, v34
    v_exp_f32 v35, v35
    v_exp_f32 v36, v36
    v_exp_f32 v37, v37
    v_exp_f32 v38, v38
    v_exp_f32 v39, v39
    v_exp_f32 v40, v40
    v_exp_f32 v41, v41
    v_exp_f32 v42, v42
    v_exp_f32 v43, v43
    v_exp_f32 v44, v44
    v_exp_f32 v45, v45
    v_exp_f32 v46, v46
    v_exp_f32 v47, v47
    v_exp_f32 v48, v48
    v_exp_f32 v49, v49
    v_exp_f32 v50, v50
    v_exp_f32 v51, v51
    v_exp_f32 v52, v52
    v_exp_f32 v53, v53
    v_exp_f32 v54, v54
    v_exp_f32 v55, v55
    v_cvt_pk_bf16_f32 v88, v24, v25
    v_cvt_pk_bf16_f32 v89, v26, v27
    v_cvt_pk_bf16_f32 v90, v28, v29
    v_cvt_pk_bf16_f32 v91, v30, v31
    v_cvt_pk_bf16_f32 v92, v32, v33
    v_cvt_pk_bf16_f32 v93, v34, v35
    v_cvt_pk_bf16_f32 v94, v36, v37
    v_cvt_pk_bf16_f32 v95, v38, v39
    v_cvt_pk_bf16_f32 v96, v40, v41
    v_cvt_pk_bf16_f32 v97, v42, v43
    v_cvt_pk_bf16_f32 v98, v44, v45
    v_cvt_pk_bf16_f32 v99, v46, v47
    v_cvt_pk_bf16_f32 v100, v48, v49
    v_cvt_pk_bf16_f32 v101, v50, v51
    v_cvt_pk_bf16_f32 v102, v52, v53
    v_cvt_pk_bf16_f32 v103, v54, v55
    s_nop 1
    v_mfma_f32_32x32x16_bf16 v[104:119], v[152:155], v[88:91], v[104:119]
    v_mfma_f32_32x32x16_bf16 v[104:119], v[156:159], v[92:95], v[104:119]
    v_mfma_f32_32x32x16_bf16 v[104:119], v[160:163], v[96:99], v[104:119]
    v_mfma_f32_32x32x16_bf16 v[104:119], v[164:167], v[100:103], v[104:119]
    s_add_u32 s60, s60, 5120
    s_sub_u32 s61, s61, 1
    s_cmp_lg_u32 s61, 0
    s_cbranch_scc1 L_at_sl2
    s_nop 11
    s_mov_b32 vcc_lo, 0
    s_mov_b32 vcc_hi, -1
    v_cndmask_b32 v58, v116, v112, vcc
    v_rcp_f32 v56, v58
    s_nop 0
    v_pk_mul_f32 v[60:61], v[56:57], v[104:105] op_sel_hi:[0,1]
    v_pk_mul_f32 v[62:63], v[56:57], v[106:107] op_sel_hi:[0,1]
    v_pk_mul_f32 v[64:65], v[56:57], v[108:109] op_sel_hi:[0,1]
    v_pk_mul_f32 v[66:67], v[56:57], v[110:111] op_sel_hi:[0,1]
    v_pk_mul_f32 v[68:69], v[56:57], v[112:113] op_sel_hi:[0,1]
    v_pk_mul_f32 v[70:71], v[56:57], v[114:115] op_sel_hi:[0,1]
    v_cvt_pk_bf16_f32 v144, v60, v61
    v_cvt_pk_bf16_f32 v145, v62, v63
    v_cvt_pk_bf16_f32 v146, v64, v65
    v_cvt_pk_bf16_f32 v147, v66, v67
    v_cvt_pk_bf16_f32 v148, v68, v69
    v_cvt_pk_bf16_f32 v149, v70, v71
    buffer_store_dwordx4 v[144:147], v188, s[24:27], s70 offen sc1
    s_mov_b32 exec_hi, 0
    buffer_store_dwordx2 v[148:149], v189, s[24:27], s71 offen sc1
    s_mov_b64 exec, -1
    v_mov_b32 v8, v12
    v_mov_b32 v9, v13
    v_mov_b32 v10, v14
    v_mov_b32 v11, v15
    v_mov_b32 v16, v18
    v_mov_b32 v17, v19
    s_mov_b32 s70, s74
    s_mov_b32 s71, s75
    s_sub_u32 s63, s63, 1
    s_cmp_lg_u32 s63, 0
    s_cbranch_scc1 L_at_sl0
    s_waitcnt vmcnt(0)
    s_branch L_at_end
S_pv:
    s_cmp_lg_u32 s29, 1
    s_cbranch_scc1 L_at_pvd
    s_lshl_b32 s60, s4, 5
    s_add_u32 s60, s60, s5
    s_lshl_b32 s60, s60, 2
    s_add_u32 s60, s60, s6
    v_min_u32 v8, 19, v1
    v_lshlrev_b32 v8, 7, v8
    v_min_u32 v9, 47, v1
    v_lshlrev_b32 v9, 7, v9
    s_mul_i32 s61, s60, 2560
    s_add_u32 s61, s61, s7
    s_add_u32 s62, s61, 2670592
    buffer_load_dword v10, v8, s[24:27], s62 offen sc1
    s_mul_i32 s62, s60, 6144
    s_add_u32 s62, s62, s7
    s_add_u32 s62, s62, 16039936
    buffer_load_dword v10, v9, s[24:27], s62 offen sc1
    s_and_b32 s62, s60, 127
    s_lshr_b32 s63, s62, 4
    s_lshl_b32 s63, s63, 14
    s_and_b32 s62, s62, 15
    s_lshl_b32 s62, s62, 7
    s_add_u32 s62, s62, s63
    s_lshl_b32 s63, s4, 11
    s_add_u32 s62, s62, s63
    s_add_u32 s62, s62, s7
    s_add_u32 s63, s62, 5423104
    buffer_load_dword v10, off, s[24:27], s63 sc1
    v_min_u32 v9, 2, v1
    v_lshlrev_b32 v9, 10, v9
    s_lshl_b32 s63, s4, 7
    s_add_u32 s63, s63, s7
    s_add_u32 s63, s63, 0
    buffer_load_dword v10, v9, s[24:27], s63 offen sc1
    s_cmp_lg_u32 s7, 0
    s_cbranch_scc1 L_at_pvd
    s_add_u32 s63, s62, 27623424
    buffer_load_dword v10, off, s[24:27], s63 sc1
    s_add_u32 s62, s61, 22380544
    buffer_load_dword v10, v8, s[24:27], s62 offen sc1
L_at_pvd:
    s_setpc_b64 s[32:33]
S_tl:
    s_mul_i32 s60, s37, 48
    s_add_u32 s60, s60, s6
    s_mul_i32 s60, s60, 5120
    s_add_u32 s60, s60, 49496064
    buffer_load_dwordx4 v[160:163], v3, s[24:27], s60 offen offset:0 sc1
    buffer_load_dwordx4 v[164:167], v3, s[24:27], s60 offen offset:1024 sc1
    buffer_load_dwordx4 v[168:171], v3, s[24:27], s60 offen offset:2048 sc1
    buffer_load_dwordx4 v[172:175], v3, s[24:27], s60 offen offset:3072 sc1
    s_add_u32 s60, s60, 4096
    buffer_load_dwordx4 v[176:179], v3, s[24:27], s60 offen offset:0 sc1
    s_add_u32 s60, s60, 16384
    buffer_load_dwordx4 v[180:183], v3, s[24:27], s60 offen offset:0 sc1
    buffer_load_dwordx4 v[184:187], v3, s[24:27], s60 offen offset:1024 sc1
    buffer_load_dwordx4 v[188:191], v3, s[24:27], s60 offen offset:2048 sc1
    buffer_load_dwordx4 v[192:195], v3, s[24:27], s60 offen offset:3072 sc1
    s_add_u32 s60, s60, 4096
    buffer_load_dwordx4 v[196:199], v3, s[24:27], s60 offen offset:0 sc1
    s_add_u32 s60, s60, 16384
    buffer_load_dwordx4 v[200:203], v3, s[24:27], s60 offen offset:0 sc1
    buffer_load_dwordx4 v[204:207], v3, s[24:27], s60 offen offset:1024 sc1
    buffer_load_dwordx4 v[208:211], v3, s[24:27], s60 offen offset:2048 sc1
    buffer_load_dwordx4 v[212:215], v3, s[24:27], s60 offen offset:3072 sc1
    s_add_u32 s60, s60, 4096
    buffer_load_dwordx4 v[216:219], v3, s[24:27], s60 offen offset:0 sc1
    s_add_u32 s60, s60, 16384
    buffer_load_dwordx4 v[220:223], v3, s[24:27], s60 offen offset:0 sc1
    buffer_load_dwordx4 v[224:227], v3, s[24:27], s60 offen offset:1024 sc1
    buffer_load_dwordx4 v[228:231], v3, s[24:27], s60 offen offset:2048 sc1
    buffer_load_dwordx4 v[232:235], v3, s[24:27], s60 offen offset:3072 sc1
    s_add_u32 s60, s60, 4096
    buffer_load_dwordx4 v[236:239], v3, s[24:27], s60 offen offset:0 sc1
    s_add_u32 s60, s60, 16384
    s_setpc_b64 s[32:33]
S_t45:
    s_mul_i32 s60, s37, 48
    s_add_u32 s60, s60, s6
    s_mul_i32 s60, s60, 5120
    s_add_u32 s60, s60, 49577984
    buffer_load_dwordx4 v[112:115], v3, s[24:27], s60 offen offset:0 sc1
    buffer_load_dwordx4 v[116:119], v3, s[24:27], s60 offen offset:1024 sc1
    buffer_load_dwordx4 v[120:123], v3, s[24:27], s60 offen offset:2048 sc1
    buffer_load_dwordx4 v[124:127], v3, s[24:27], s60 offen offset:3072 sc1
    s_add_u32 s60, s60, 4096
    buffer_load_dwordx4 v[128:131], v3, s[24:27], s60 offen offset:0 sc1
    s_add_u32 s60, s60, 16384
    buffer_load_dwordx4 v[132:135], v3, s[24:27], s60 offen offset:0 sc1
    buffer_load_dwordx4 v[136:139], v3, s[24:27], s60 offen offset:1024 sc1
    buffer_load_dwordx4 v[140:143], v3, s[24:27], s60 offen offset:2048 sc1
    buffer_load_dwordx4 v[144:147], v3, s[24:27], s60 offen offset:3072 sc1
    s_add_u32 s60, s60, 4096
    buffer_load_dwordx4 v[148:151], v3, s[24:27], s60 offen offset:0 sc1
    s_add_u32 s60, s60, 16384
    s_setpc_b64 s[32:33]
S_t67:
    s_mul_i32 s60, s37, 48
    s_add_u32 s60, s60, s6
    s_mul_i32 s60, s60, 5120
    s_add_u32 s60, s60, 49618944
    buffer_load_dwordx4 v[16:19], v3, s[24:27], s60 offen offset:0 sc1
    buffer_load_dwordx4 v[20:23], v3, s[24:27], s60 offen offset:1024 sc1
    buffer_load_dwordx4 v[24:27], v3, s[24:27], s60 offen offset:2048 sc1
    buffer_load_dwordx4 v[28:31], v3, s[24:27], s60 offen offset:3072 sc1
    s_add_u32 s60, s60, 4096
    buffer_load_dwordx4 v[32:35], v3, s[24:27], s60 offen offset:0 sc1
    s_add_u32 s60, s60, 16384
    buffer_load_dwordx4 v[36:39], v3, s[24:27], s60 offen offset:0 sc1
    buffer_load_dwordx4 v[40:43], v3, s[24:27], s60 offen offset:1024 sc1
    buffer_load_dwordx4 v[44:47], v3, s[24:27], s60 offen offset:2048 sc1
    buffer_load_dwordx4 v[48:51], v3, s[24:27], s60 offen offset:3072 sc1
    s_add_u32 s60, s60, 4096
    buffer_load_dwordx4 v[52:55], v3, s[24:27], s60 offen offset:0 sc1
    s_add_u32 s60, s60, 16384
    s_setpc_b64 s[32:33]
S_wot:
    s_lshl_b32 s61, s6, 10
    v_mov_b32 v4, s61
    s_mov_b32 s45, 0x100000
L_at_mk:
    ds_read_b128 v[8:11], v4
    s_waitcnt lgkmcnt(0)
    v_min3_u32 v5, v8, v9, v10
    v_max3_u32 v6, v8, v9, v10
    v_min_u32 v5, v5, v11
    v_max_u32 v6, v6, v11
    v_cmp_ne_u32 vcc, s28, v5
    v_cmp_ne_u32 s[62:63], s28, v6
    s_sub_u32 s45, s45, 1
    s_cmp_eq_u32 s45, 0
    s_cbranch_scc1 L_at_mkd
    s_or_b64 vcc, vcc, s[62:63]
    s_cbranch_scc0 L_at_mkd
    s_sleep 16
    s_branch L_at_mk
L_at_mkd:
    s_mul_i32 s60, s37, 102400
    s_add_u32 s60, s60, s61
    s_add_u32 s60, s60, 48594944
    s_mov_b32 m0, s61
    s_mov_b32 s62, 25
L_at_wdma:
    buffer_load_dwordx4 v3, s[24:27], s60 offen sc1 lds
    s_add_u32 m0, m0, 4096
    s_add_u32 s60, s60, 4096
    s_sub_u32 s62, s62, 1
    s_cmp_lg_u32 s62, 0
    s_cbranch_scc1 L_at_wdma
    s_setpc_b64 s[32:33]
L_code_end:
    s_endpgm
.section .rodata,"a"
.p2align 6
.amdhsa_kernel interleave_layers__softmax_full_mha__glu_gated_reglu__prompt_kernel
  .amdhsa_next_free_vgpr 256
  .amdhsa_next_free_sgpr 96
  .amdhsa_accum_offset 256
  .amdhsa_group_segment_fixed_size 0
  .amdhsa_kernarg_size 80
  .amdhsa_user_sgpr_count 2
  .amdhsa_user_sgpr_kernarg_segment_ptr 1
  .amdhsa_system_sgpr_workgroup_id_x 1
.end_amdhsa_kernel
```
